```python
import torch

def _softmax(x, axis=-1):
    return torch.softmax(x, dim=axis)
def _gelu(x):
    return torch.nn.functional.gelu(x, approximate="tanh")
def _silu(x):
    return torch.nn.functional.silu(x)
def _sigmoid(x):
    return torch.sigmoid(x)
def _layernorm(x, axis=-1, eps=1e-5):
    m = x.mean(dim=axis, keepdim=True)
    v = x.var(dim=axis, keepdim=True, unbiased=False)
    return (x - m) / torch.sqrt(v + eps)
def _scatter_add(tgt, idx, src, axis=0):
    return tgt.clone().index_add_(axis, idx, src)
def _segment_sum(src, seg, n):
    out = torch.zeros((n,) + src.shape[1:], dtype=src.dtype)
    return out.index_add_(0, seg, src)
def _pad(x, pw):
    flat = tuple(v for pair in reversed(pw) for v in pair)
    return torch.nn.functional.pad(x, flat)

kernel_name = 'sequential_preLN__compressed_kv_cla__dense_activation_squared_relu__decode'

def setup_inputs():

    _w = (lambda a: (lambda t: t.to(torch.bfloat16) if t.is_floating_point() else t)(torch.as_tensor(a)))
    def _A_setup():
        B, H, Sq, Sk, D, M = 1, 32, 1, 16384, 128, 640
        Dc = 4 * D
        return {
            "x": _w((lambda *s: torch.randn(*s, dtype=torch.bfloat16) * 0.05)(B, Sq, M)),
            "c_kv": _w((lambda *s: torch.randn(*s, dtype=torch.bfloat16) * 0.4)(B, Sk, Dc)),
            "w_q": _w((lambda *s: torch.randn(*s, dtype=torch.bfloat16) * 3.2)(M, H, D) * (M ** -0.5)),
            "w_uk": _w((lambda *s: torch.randn(*s, dtype=torch.bfloat16) * 3.2)(Dc, H, D) * (Dc ** -0.5)),
            "w_uv": _w((lambda *s: torch.randn(*s, dtype=torch.bfloat16) * 0.4)(Dc, H, D) * (Dc ** -0.5)),
            "w_o": _w((lambda *s: torch.randn(*s, dtype=torch.bfloat16) * 0.4)(H, D, M) * ((H * D) ** -0.5)),
        }
    _A_in = _A_setup()

    def _B_setup():
        B, S, D, F = 1, 1, 640, 1728
        return {
            "x": _w((lambda *s: torch.randn(*s, dtype=torch.bfloat16) * 0.05)(B, S, D)),
            "w1": _w((lambda *s: torch.randn(*s, dtype=torch.bfloat16) * 0.05)(D, F)),
            "b1": _w((lambda *s: torch.randn(*s, dtype=torch.bfloat16) * 0.4)(F)),
            "w2": _w((lambda *s: torch.randn(*s, dtype=torch.bfloat16) * 0.05)(F, D)),
            "b2": _w((lambda *s: torch.randn(*s, dtype=torch.bfloat16) * 1.6)(D)),
        }
    _B_in = _B_setup()

    return {
        "A_x": _A_in["x"],
        "A_c_kv": _A_in["c_kv"],
        "A_w_q": _A_in["w_q"],
        "A_w_uk": _A_in["w_uk"],
        "A_w_uv": _A_in["w_uv"],
        "A_w_o": _A_in["w_o"],
        "B_x": _B_in["x"],
        "B_w1": _B_in["w1"],
        "B_b1": _B_in["b1"],
        "B_w2": _B_in["w2"],
        "B_b2": _B_in["b2"],
    }

def reference(A_x, A_c_kv, A_w_q, A_w_uk, A_w_uv, A_w_o, B_x, B_w1, B_b1, B_w2, B_b2):
    def _A_ref(x, c_kv, w_q, w_uk, w_uv, w_o):
        B, Sq, M = x.shape[0], x.shape[1], x.shape[2]
        Sk = c_kv.shape[1]
        H, D = w_q.shape[1], w_q.shape[2]
        q = torch.einsum("bqm,mhd->bhqd", x, w_q)
        k = torch.einsum("bkc,chd->bhkd", c_kv, w_uk)
        v = torch.einsum("bkc,chd->bhkd", c_kv, w_uv)
        scores = torch.einsum("bhqd,bhkd->bhqk", q, k) * (D ** -0.5)
        off = Sk - Sq
        qi = torch.arange(Sq)[:, None]
        kj = torch.arange(Sk)[None, :]
        cmask = kj <= (qi + off)
        scores = torch.where(cmask[None, None], scores, -1e9)
        p = _softmax(scores, axis=-1)
        ctx = torch.einsum("bhqk,bhkd->bhqd", p, v)
        return torch.einsum("bhqd,hdm->bqm", ctx, w_o)

    def _B_ref(x, w1, b1, w2, b2):
        h = torch.einsum("bsd,df->bsf", x, w1) + b1
        zero = torch.zeros_like(h)
        r = torch.where(h > zero, h, zero)
        h = r * r
        out = torch.einsum("bsf,fd->bsd", h, w2) + b2
        return out

    x = A_x
    h = x + _A_ref(_layernorm(x, axis=-1), A_c_kv, A_w_q, A_w_uk, A_w_uv, A_w_o)
    h2 = h + _B_ref(_layernorm(h, axis=-1), B_w1, B_b1, B_w2, B_b2)
    return h2
```

```asm
; @launch grid=(256,1,1) block=(256,1,1) lds=163840
.amdgcn_target "amdgcn-amd-amdhsa--gfx950"
.text
.globl sequential_preLN__compressed_kv_cla__dense_activation_squared_relu__decode_kernel
.p2align 12
.p2align 8
.type sequential_preLN__compressed_kv_cla__dense_activation_squared_relu__decode_kernel,@function
sequential_preLN__compressed_kv_cla__dense_activation_squared_relu__decode_kernel:
  s_load_dwordx16 s[8:23], s[0:1], 0
  s_cmp_ge_u32 s2, 256
  s_cbranch_scc1 L_EXIT
  v_lshrrev_b32 v1, 6, v0
  v_and_b32 v0, 63, v0
  v_readfirstlane_b32 s36, v1
  v_and_b32 v1, 15, v0
  v_lshrrev_b32 v2, 4, v0
  v_lshlrev_b32 v4, 2, v0
  s_and_b32 s37, s2, 7
  s_lshr_b32 s38, s2, 3
  v_lshlrev_b32 v5, 4, v1
  v_lshlrev_b32 v6, 5, v2
  v_xor_b32 v5, v5, v6
  v_lshl_add_u32 v6, v2, 13, v5
  s_lshr_b32 s67, s36, 1
  s_lshl_b32 s67, s67, 7
  v_xor_b32 v8, s67, v6
  s_bfe_u32 s60, s38, 0x20002
  s_mul_i32 s60, s60, 1310720
  s_and_b32 s63, s38, 3
  s_lshl2_add_u32 s63, s37, s63
  s_lshl_b32 s63, s63, 8
  s_add_u32 s60, s60, s63
  s_lshl_b32 s61, s36, 15
  s_lshl_b32 s62, s36, 10
  s_mov_b32 s51, 0x20000
  s_mov_b32 s59, s51
  s_sub_u32 s50, 5242880, s60
  s_cmp_lt_u32 s38, 16
  s_cselect_b32 s58, 64, 1280
  s_cselect_b32 s66, s38, 0
  s_cselect_b32 s64, 655360, 0
  s_cselect_b32 s65, 61440, 0
  s_add_u32 s61, s61, s64
  s_add_u32 s62, s62, s65
  s_add_u32 s62, s62, 69632
  s_lshl_b32 s66, s66, 18
  s_cmp_lt_u32 s38, 16
  s_waitcnt lgkmcnt(0)
  s_load_dwordx4 s[32:35], s[0:1], 96
  s_load_dwordx8 s[24:31], s[0:1], 64
  s_cselect_b64 s[56:57], s[14:15], s[8:9]
  s_and_b32 s57, s57, 0xffff
  s_add_u32 s56, s56, s66
  s_addc_u32 s57, s57, 0
  s_add_u32 s48, s12, s60
  s_addc_u32 s49, s13, 0
  s_and_b32 s49, s49, 0xffff
  buffer_load_dword v240, v4, s[56:59], 0 offen offset:0
  buffer_load_dword v241, v4, s[56:59], 0 offen offset:256
  buffer_load_dword v242, v4, s[56:59], 0 offen offset:512
  buffer_load_dword v243, v4, s[56:59], 0 offen offset:768
  buffer_load_dword v244, v4, s[56:59], 0 offen offset:1024
  s_cmp_lt_u32 s38, 16
  s_cbranch_scc1 L_SKIPQ
  s_add_u32 m0, s62, 0
  s_nop 0
  buffer_load_dwordx4 v8, s[48:51], s61 offen nt lds
  s_add_u32 s61, s61, 131072
  s_add_u32 m0, s62, 4096
  s_nop 0
  buffer_load_dwordx4 v8, s[48:51], s61 offen nt lds
  s_add_u32 s61, s61, 131072
  s_add_u32 m0, s62, 8192
  s_nop 0
  buffer_load_dwordx4 v8, s[48:51], s61 offen nt lds
  s_add_u32 s61, s61, 131072
  s_add_u32 m0, s62, 12288
  s_nop 0
  buffer_load_dwordx4 v8, s[48:51], s61 offen nt lds
  s_add_u32 s61, s61, 131072
  s_add_u32 m0, s62, 16384
  s_nop 0
  buffer_load_dwordx4 v8, s[48:51], s61 offen nt lds
  s_add_u32 s61, s61, 131072
L_SKIPQ:
  v_lshlrev_b32 v3, 4, v0
  v_mov_b32 v9, 2147483632
  v_lshlrev_b32 v11, 4, v2
  s_mov_b32 s42, 400000
  s_mov_b32 s3, -1
  s_mov_b32 s4, 0
  s_mov_b32 s5, 1048576
  s_mov_b32 s46, 7340032
  s_mov_b32 s47, 0x20000
  s_cmp_lt_u32 s38, 16
  s_cbranch_scc0 L_A
L_T:
  s_lshl_b32 s72, s37, 4
  s_add_u32 s72, s72, s38
  s_lshl_b32 s63, s72, 17
  s_add_u32 s52, s10, s63
  s_addc_u32 s53, s11, 0
  s_and_b32 s53, s53, 0xffff
  s_sub_u32 s54, 16777216, s63
  s_mov_b32 s55, 0x20000
  v_lshl_add_u32 v52, v2, 10, v5
  v_xor_b32 v53, 0x80, v52
  s_lshl_b32 s68, s36, 15
  s_lshl_b32 s69, s36, 13
  s_lshl1_add_u32 s63, s36, s38
  s_and_b32 s63, s63, 7
  s_lshl_b32 s63, s63, 12
  s_or_b32 s68, s68, s63
  s_branch L_T1
L_A:
  s_sub_u32 s72, s38, 16
  s_add_u32 m0, s62, 20480
  s_nop 0
  buffer_load_dwordx4 v8, s[48:51], s61 offen nt lds
  s_add_u32 s61, s61, 131072
  s_add_u32 m0, s62, 24576
  s_nop 0
  buffer_load_dwordx4 v8, s[48:51], s61 offen nt lds
  s_add_u32 s61, s61, 131072
  s_add_u32 m0, s62, 28672
  s_nop 0
  buffer_load_dwordx4 v8, s[48:51], s61 offen nt lds
  s_add_u32 s61, s61, 131072
  s_add_u32 m0, s62, 32768
  s_nop 0
  buffer_load_dwordx4 v8, s[48:51], s61 offen nt lds
  s_add_u32 s61, s61, 131072
  s_add_u32 m0, s62, 36864
  s_nop 0
  buffer_load_dwordx4 v8, s[48:51], s61 offen nt lds
  s_waitcnt lgkmcnt(0)
  s_mov_b32 s44, s34
  s_and_b32 s45, s35, 0xffff
  s_load_dword s39, s[34:35], 0
  s_lshl_b32 s63, s37, 2
  s_and_b32 s73, s72, 3
  s_add_u32 s73, s73, s63
  s_lshr_b32 s74, s72, 2
  s_lshl_b32 s66, s37, 4
  s_add_u32 s66, s66, s72
  v_lshrrev_b32 v12, 2, v1
  v_lshl_add_u32 v13, v2, 3, v12
  v_lshlrev_b32 v13, 8, v13
  v_and_b32 v14, 3, v1
  v_lshl_add_u32 v13, v14, 3, v13
  v_and_b32 v15, 1, v2
  v_lshl_or_b32 v15, v15, 2, v12
  s_lshl_b32 s63, s36, 1
  v_xor_b32 v15, s63, v15
  v_lshl_add_u32 v60, v15, 5, v13
  v_xor_b32 v15, 1, v15
  v_lshl_add_u32 v61, v15, 5, v13
  v_add_u32 v56, 69632, v60
  v_add_u32 v57, 69632, v61
  v_lshl_add_u32 v12, v1, 6, v11
  s_and_b32 s63, s38, 3
  s_lshl_b32 s64, s37, 2
  s_add_u32 s63, s63, s64
  s_lshl_b32 s63, s63, 2
  s_bfe_u32 s64, s38, 0x20002
  s_add_u32 s63, s63, s64
  s_lshl_b32 s63, s63, 9
  s_lshl_b32 s64, s36, 7
  s_add_u32 s63, s63, s64
  s_add_u32 s63, s63, 32768
  v_add_u32 v12, s63, v12
  v_cmp_gt_u32 vcc, 2, v1
  s_nop 1
  v_cndmask_b32 v62, v9, v12, vcc
  v_cmp_eq_u32 s[70:71], 1, v1
  s_mul_i32 s63, s36, 1280
  s_add_u32 s63, s63, 110592
  v_add_u32 v10, s63, v4
  s_bfe_u32 s64, s38, 0x20002
  s_mul_i32 s64, s64, 320
  s_add_u32 s63, s63, s64
  v_add_u32 v12, s63, v11
  s_waitcnt vmcnt(10)
  v_lshlrev_b32 v26, 16, v240
  v_and_b32 v27, 0xffff0000, v240
  v_lshlrev_b32 v28, 16, v241
  v_and_b32 v29, 0xffff0000, v241
  v_lshlrev_b32 v30, 16, v242
  v_and_b32 v31, 0xffff0000, v242
  v_lshlrev_b32 v32, 16, v243
  v_and_b32 v33, 0xffff0000, v243
  v_lshlrev_b32 v34, 16, v244
  v_and_b32 v35, 0xffff0000, v244
  v_pk_add_f32 v[36:37], v[26:27], v[28:29]
  v_pk_add_f32 v[38:39], v[30:31], v[32:33]
  v_pk_add_f32 v[36:37], v[36:37], v[34:35]
  v_pk_add_f32 v[36:37], v[36:37], v[38:39]
  v_add_f32 v36, v36, v37
  s_nop 1
  v_add_f32_dpp v36, v36, v36 quad_perm:[1,0,3,2] row_mask:0xf bank_mask:0xf
  s_nop 1
  v_add_f32_dpp v36, v36, v36 quad_perm:[2,3,0,1] row_mask:0xf bank_mask:0xf
  s_nop 1
  v_add_f32_dpp v36, v36, v36 row_half_mirror row_mask:0xf bank_mask:0xf
  s_nop 1
  v_add_f32_dpp v36, v36, v36 row_mirror row_mask:0xf bank_mask:0xf
  v_mov_b32 v37, v36
  s_nop 1
  v_permlane16_swap_b32 v36, v37
  v_add_f32 v36, v36, v37
  v_mov_b32 v37, v36
  s_nop 1
  v_permlane32_swap_b32 v36, v37
  v_add_f32 v36, v36, v37
  v_mul_f32 v36, 0xbacccccd, v36
  v_mov_b32 v37, v36
  v_pk_add_f32 v[26:27], v[26:27], v[36:37]
  v_pk_add_f32 v[28:29], v[28:29], v[36:37]
  v_pk_add_f32 v[30:31], v[30:31], v[36:37]
  v_pk_add_f32 v[32:33], v[32:33], v[36:37]
  v_pk_add_f32 v[34:35], v[34:35], v[36:37]
  v_pk_mul_f32 v[36:37], v[26:27], v[26:27]
  v_pk_fma_f32 v[36:37], v[28:29], v[28:29], v[36:37]
  v_pk_fma_f32 v[36:37], v[30:31], v[30:31], v[36:37]
  v_pk_fma_f32 v[36:37], v[32:33], v[32:33], v[36:37]
  v_pk_fma_f32 v[36:37], v[34:35], v[34:35], v[36:37]
  v_add_f32 v36, v36, v37
  s_nop 1
  v_add_f32_dpp v36, v36, v36 quad_perm:[1,0,3,2] row_mask:0xf bank_mask:0xf
  s_nop 1
  v_add_f32_dpp v36, v36, v36 quad_perm:[2,3,0,1] row_mask:0xf bank_mask:0xf
  s_nop 1
  v_add_f32_dpp v36, v36, v36 row_half_mirror row_mask:0xf bank_mask:0xf
  s_nop 1
  v_add_f32_dpp v36, v36, v36 row_mirror row_mask:0xf bank_mask:0xf
  v_mov_b32 v37, v36
  s_nop 1
  v_permlane16_swap_b32 v36, v37
  v_add_f32 v36, v36, v37
  v_mov_b32 v37, v36
  s_nop 1
  v_permlane32_swap_b32 v36, v37
  v_add_f32 v36, v36, v37
  v_mul_f32 v36, 0x3acccccd, v36
  v_add_f32 v36, 0x3727c5ac, v36
  v_rsq_f32 v36, v36
  s_nop 0
  v_mov_b32 v37, v36
  v_pk_mul_f32 v[26:27], v[26:27], v[36:37]
  v_pk_mul_f32 v[28:29], v[28:29], v[36:37]
  v_pk_mul_f32 v[30:31], v[30:31], v[36:37]
  v_pk_mul_f32 v[32:33], v[32:33], v[36:37]
  v_pk_mul_f32 v[34:35], v[34:35], v[36:37]
  v_cvt_pk_bf16_f32 v20, v26, v27
  ds_write_b32 v10, v20 offset:0
  v_cvt_pk_bf16_f32 v21, v28, v29
  ds_write_b32 v10, v21 offset:256
  v_cvt_pk_bf16_f32 v22, v30, v31
  ds_write_b32 v10, v22 offset:512
  v_cvt_pk_bf16_f32 v23, v32, v33
  ds_write_b32 v10, v23 offset:768
  v_cvt_pk_bf16_f32 v24, v34, v35
  ds_write_b32 v10, v24 offset:1024
  ds_read_b128 v[36:39], v12 offset:0
  ds_read_b128 v[40:43], v12 offset:64
  ds_read_b128 v[44:47], v12 offset:128
  ds_read_b128 v[48:51], v12 offset:192
  ds_read_b128 v[52:55], v12 offset:256
  s_lshl_b32 s63, s37, 2
  s_add_u32 s64, s63, s36
  s_lshl_b32 s64, s64, 8
  s_lshl_b32 s65, s72, 18
  s_add_u32 s64, s64, s65
  s_add_u32 s52, s14, s64
  s_addc_u32 s53, s15, 0
  s_and_b32 s53, s53, 0xffff
  s_sub_u32 s54, 4194304, s64
  s_mov_b32 s55, 0x20000
  v_xor_b32 v7, 0x80, v6
  s_mov_b32 s68, 0
  s_lshl_b32 s69, s36, 13
  s_add_u32 m0, s69, 4096
  s_nop 0
  buffer_load_dwordx4 v6, s[52:55], s68 offen nt lds
  s_add_u32 s68, s68, 32768
  s_add_u32 m0, s69, 5120
  s_nop 0
  buffer_load_dwordx4 v6, s[52:55], s68 offen nt lds
  s_add_u32 s68, s68, 32768
  s_add_u32 m0, s69, 6144
  s_nop 0
  buffer_load_dwordx4 v7, s[52:55], s68 offen nt lds
  s_add_u32 s68, s68, 32768
  s_add_u32 m0, s69, 7168
  s_nop 0
  buffer_load_dwordx4 v7, s[52:55], s68 offen nt lds
  s_add_u32 s68, s68, 32768
  s_add_u32 m0, s69, 8192
  s_nop 0
  buffer_load_dwordx4 v6, s[52:55], s68 offen nt lds
  s_add_u32 s68, s68, 32768
  s_add_u32 m0, s69, 9216
  s_nop 0
  buffer_load_dwordx4 v6, s[52:55], s68 offen nt lds
  s_add_u32 s68, s68, 32768
  s_add_u32 m0, s69, 10240
  s_nop 0
  buffer_load_dwordx4 v7, s[52:55], s68 offen nt lds
  s_add_u32 s68, s68, 32768
  s_add_u32 m0, s69, 11264
  s_nop 0
  buffer_load_dwordx4 v7, s[52:55], s68 offen nt lds
  s_waitcnt vmcnt(8) lgkmcnt(0)
  s_barrier
  ds_read_b64_tr_b16 v[128:129], v56 offset:0
  ds_read_b64_tr_b16 v[130:131], v56 offset:1024
  ds_read_b64_tr_b16 v[132:133], v57 offset:0
  ds_read_b64_tr_b16 v[134:135], v57 offset:1024
  ds_read_b64_tr_b16 v[136:137], v56 offset:8192
  ds_read_b64_tr_b16 v[138:139], v56 offset:9216
  ds_read_b64_tr_b16 v[140:141], v57 offset:8192
  ds_read_b64_tr_b16 v[142:143], v57 offset:9216
  ds_read_b64_tr_b16 v[144:145], v56 offset:16384
  ds_read_b64_tr_b16 v[146:147], v56 offset:17408
  ds_read_b64_tr_b16 v[148:149], v57 offset:16384
  ds_read_b64_tr_b16 v[150:151], v57 offset:17408
  ds_read_b64_tr_b16 v[152:153], v56 offset:24576
  ds_read_b64_tr_b16 v[154:155], v56 offset:25600
  ds_read_b64_tr_b16 v[156:157], v57 offset:24576
  ds_read_b64_tr_b16 v[158:159], v57 offset:25600
  ds_read_b64_tr_b16 v[160:161], v56 offset:32768
  ds_read_b64_tr_b16 v[162:163], v56 offset:33792
  ds_read_b64_tr_b16 v[164:165], v57 offset:32768
  ds_read_b64_tr_b16 v[166:167], v57 offset:33792
  s_add_u32 s40, s39, 0x9e3779b9
  s_xor_b32 s41, s40, 0x5bd1e995
  v_mov_b32 v18, s40
  v_mov_b32 v19, s41
  s_waitcnt lgkmcnt(15)
  v_mfma_f32_16x16x32_bf16 v[84:87], v[128:131], v[36:39], 0
  s_waitcnt lgkmcnt(15)
  v_mfma_f32_16x16x32_bf16 v[88:91], v[132:135], v[36:39], 0
  s_waitcnt lgkmcnt(14)
  v_mfma_f32_16x16x32_bf16 v[84:87], v[136:139], v[40:43], v[84:87]
  s_waitcnt lgkmcnt(12)
  v_mfma_f32_16x16x32_bf16 v[88:91], v[140:143], v[40:43], v[88:91]
  s_waitcnt lgkmcnt(10)
  v_mfma_f32_16x16x32_bf16 v[84:87], v[144:147], v[44:47], v[84:87]
  s_waitcnt lgkmcnt(8)
  v_mfma_f32_16x16x32_bf16 v[88:91], v[148:151], v[44:47], v[88:91]
  s_waitcnt lgkmcnt(6)
  v_mfma_f32_16x16x32_bf16 v[84:87], v[152:155], v[48:51], v[84:87]
  s_waitcnt lgkmcnt(4)
  v_mfma_f32_16x16x32_bf16 v[88:91], v[156:159], v[48:51], v[88:91]
  s_waitcnt lgkmcnt(2)
  v_mfma_f32_16x16x32_bf16 v[84:87], v[160:163], v[52:55], v[84:87]
  s_waitcnt lgkmcnt(0)
  v_mfma_f32_16x16x32_bf16 v[88:91], v[164:167], v[52:55], v[88:91]
  s_nop 5
  v_cvt_pk_bf16_f32 v92, v84, v85
  v_cvt_pk_bf16_f32 v93, v86, v87
  v_cvt_pk_bf16_f32 v94, v88, v89
  v_cvt_pk_bf16_f32 v95, v90, v91
  v_cndmask_b32 v16, v92, v94, s[70:71]
  v_cndmask_b32 v17, v93, v95, s[70:71]
  buffer_store_dwordx4 v[16:19], v62, s[44:47], s5 offen
  s_and_b32 s63, s37, 6
  s_add_u32 s63, s63, s37
  s_lshl2_add_u32 s63, s63, s36
  s_lshl4_add_u32 s63, s63, s72
  s_lshl_b32 s63, s63, 6
  s_add_u32 s63, s63, 163840
  v_lshlrev_b32 v14, 13, v2
  v_lshl_add_u32 v12, v1, 2, v14
  v_add_u32 v12, s63, v12
  s_lshl2_add_u32 s64, s66, s36
  s_lshl_b32 s63, s64, 7
  s_add_u32 s63, s63, 98304
  v_lshlrev_b32 v13, 3, v0
  v_add_u32 v13, s63, v13
  s_lshl_b32 s63, s64, 3
  s_add_u32 s63, s63, 229376
  v_add_u32 v14, s63, v14
  s_and_b32 s64, s72, 7
  s_lshl_b32 s64, s64, 1
  v_cmp_eq_u32 vcc, s64, v1
  s_nop 1
  v_cndmask_b32 v14, v9, v14, vcc
  v_cmp_gt_u32 vcc, 32, v0
  s_nop 1
  v_cndmask_b32 v101, v9, v12, vcc
  v_cndmask_b32 v103, v9, v14, vcc
  v_cmp_gt_u32 vcc, 16, v0
  s_nop 1
  v_cndmask_b32 v100, v9, v12, vcc
  v_cndmask_b32 v26, v9, v14, vcc
  v_cndmask_b32 v102, v9, v13, vcc
  v_mov_b32 v99, s40
  v_lshlrev_b32 v27, 9, v2
  v_lshl_add_u32 v27, v1, 4, v27
  s_lshl_b32 s65, s37, 2
  s_add_u32 s65, s65, s36
  s_lshl_b32 s65, s65, 11
  s_add_u32 s65, s65, 1081344
  v_lshlrev_b32 v12, 9, v1
  s_lshl_b32 s63, s36, 13
  s_add_u32 s63, s63, 4096
  v_add_u32 v12, s63, v12
  v_and_b32 v13, 1, v1
  v_and_b32 v14, 4, v1
  v_lshl_or_b32 v13, v13, 1, v14
  v_lshlrev_b32 v13, 5, v13
  v_add_u32 v14, 0, v11
  v_xor_b32 v14, v14, v13
  v_add_u32 v40, v14, v12
  v_xor_b32 v14, 32, v14
  v_add_u32 v41, v14, v12
  v_add_u32 v14, 64, v11
  v_xor_b32 v14, v14, v13
  v_add_u32 v42, v14, v12
  v_xor_b32 v14, 32, v14
  v_add_u32 v43, v14, v12
  v_add_u32 v14, 128, v11
  v_xor_b32 v14, v14, v13
  v_add_u32 v44, v14, v12
  v_xor_b32 v14, 32, v14
  v_add_u32 v45, v14, v12
  v_add_u32 v14, 192, v11
  v_xor_b32 v14, v14, v13
  v_add_u32 v46, v14, v12
  v_xor_b32 v14, 32, v14
  v_add_u32 v47, v14, v12
  v_and_b32 v12, 1, v1
  v_cmp_eq_u32 vcc, 1, v12
  v_mov_b32 v12, 16256
  v_mov_b32 v13, 1065353216
  v_cndmask_b32 v12, v12, v13, vcc
  v_lshrrev_b32 v13, 1, v1
  v_cmp_eq_u32 vcc, 0, v13
  s_nop 1
  v_cndmask_b32 v28, 0, v12, vcc
  v_cmp_eq_u32 vcc, 1, v13
  s_nop 1
  v_cndmask_b32 v29, 0, v12, vcc
  v_cmp_eq_u32 vcc, 2, v13
  s_nop 1
  v_cndmask_b32 v30, 0, v12, vcc
  v_cmp_eq_u32 vcc, 3, v13
  s_nop 1
  v_cndmask_b32 v31, 0, v12, vcc
  v_cmp_eq_u32 vcc, 4, v13
  s_nop 1
  v_cndmask_b32 v32, 0, v12, vcc
  v_cmp_eq_u32 vcc, 5, v13
  s_nop 1
  v_cndmask_b32 v33, 0, v12, vcc
  v_cmp_eq_u32 vcc, 6, v13
  s_nop 1
  v_cndmask_b32 v34, 0, v12, vcc
  v_cmp_eq_u32 vcc, 7, v13
  s_nop 1
  v_cndmask_b32 v35, 0, v12, vcc
  s_lshl_b32 s63, s36, 8
  v_lshlrev_b32 v12, 3, v0
  v_add_u32 v12, s63, v12
  v_mov_b32 v13, 3584
  v_cmp_gt_u32 vcc, 32, v0
  s_nop 1
  v_cndmask_b32 v24, v13, v12, vcc
  v_add_u32 v25, s63, v11
  s_waitcnt vmcnt(4)
  buffer_load_dwordx4 v[64:67], v27, s[44:47], s65 offen offset:0 sc1
  buffer_load_dwordx4 v[68:71], v27, s[44:47], s65 offen offset:256 sc1
  s_waitcnt vmcnt(3)
  ds_read_b128 v[112:115], v40 offset:0
  ds_read_b128 v[116:119], v41 offset:256
  ds_read_b128 v[120:123], v42 offset:0
  ds_read_b128 v[124:127], v43 offset:256
  ds_read_b128 v[128:131], v44 offset:0
  ds_read_b128 v[132:135], v45 offset:256
  ds_read_b128 v[136:139], v46 offset:0
  ds_read_b128 v[140:143], v47 offset:256
L_A_H0:
  s_waitcnt vmcnt(0)
  v_mfma_f32_16x16x16_bf16 v[80:83], v[28:29], v[64:65], 0
  v_mfma_f32_16x16x16_bf16 v[80:83], v[30:31], v[68:69], v[80:83]
  v_xor_b32 v66, s40, v66
  v_xor_b32 v67, s41, v67
  v_xor_b32 v70, s40, v70
  v_xor_b32 v71, s41, v71
  v_or3_b32 v12, v66, v67, v70
  v_or_b32 v12, v12, v71
  v_cmp_ne_u32 vcc, 0, v12
  s_cbranch_vccz L_A_H0OK
  s_sub_u32 s42, s42, 1
  s_cmp_eq_u32 s42, 0
  s_cbranch_scc1 L_END
  s_add_u32 s4, s4, 1
  s_cmp_ge_u32 s4, 96
  s_cselect_b32 s3, 4293918719, s3
  s_and_b32 s65, s65, s3
  s_cmp_eq_u32 s3, -1
  s_cbranch_scc1 Lnp_1
  buffer_store_dwordx4 v[16:19], v62, s[44:47], 0 offen sc1
Lnp_1:
  buffer_load_dwordx4 v[64:67], v27, s[44:47], s65 offen offset:0 sc1
  buffer_load_dwordx4 v[68:71], v27, s[44:47], s65 offen offset:256 sc1
  s_branch L_A_H0
L_A_H0OK:
  v_cvt_pk_bf16_f32 v84, v80, v81
  v_cvt_pk_bf16_f32 v85, v82, v83
  ds_write_b64 v24, v[84:85] offset:0
  ds_read_b128 v[144:147], v25 offset:0
  ds_read_b128 v[148:151], v25 offset:64
  ds_read_b128 v[152:155], v25 offset:128
  ds_read_b128 v[156:159], v25 offset:192
  s_waitcnt lgkmcnt(3)
  v_mfma_f32_16x16x32_bf16 v[104:107], v[144:147], v[112:115], 0
  v_mfma_f32_16x16x32_bf16 v[108:111], v[144:147], v[116:119], 0
  s_waitcnt lgkmcnt(2)
  v_mfma_f32_16x16x32_bf16 v[104:107], v[148:151], v[120:123], v[104:107]
  v_mfma_f32_16x16x32_bf16 v[108:111], v[148:151], v[124:127], v[108:111]
  s_waitcnt lgkmcnt(1)
  v_mfma_f32_16x16x32_bf16 v[104:107], v[152:155], v[128:131], v[104:107]
  v_mfma_f32_16x16x32_bf16 v[108:111], v[152:155], v[132:135], v[108:111]
  s_waitcnt lgkmcnt(0)
  v_mfma_f32_16x16x32_bf16 v[104:107], v[156:159], v[136:139], v[104:107]
  v_mfma_f32_16x16x32_bf16 v[108:111], v[156:159], v[140:143], v[108:111]
  s_nop 7
  v_cvt_pk_bf16_f32 v64, v104, v108
  buffer_store_dword v64, v101, s[44:47], 0 offen sc1
  buffer_store_dword v64, v100, s[44:47], s5 offen
  v_add_u32_dpp v96, v64, v64 quad_perm:[2,3,0,1] row_mask:0xf bank_mask:0xf
  v_xor_b32 v97, s40, v64
  s_nop 0
  v_add_u32_dpp v96, v96, v96 row_ror:4 row_mask:0xf bank_mask:0xf
  s_nop 1
  v_add_u32_dpp v96, v96, v96 row_ror:8 row_mask:0xf bank_mask:0xf
  buffer_store_dwordx2 v[96:97], v103, s[44:47], 0 offen sc1
  buffer_store_dwordx2 v[96:97], v26, s[44:47], s5 offen
  buffer_store_dwordx4 v[16:19], v62, s[44:47], 0 offen sc1
  s_branch L_A2
.p2align 12
L_T1:
  s_lshl_b32 s63, s72, 9
  s_add_u32 s63, s63, 1081344
  s_and_b32 s64, s72, 0x60
  s_add_u32 s64, s64, s72
  s_lshl_b32 s64, s64, 8
  s_add_u32 s64, s64, 1212416
  s_cmp_eq_u32 s36, 2
  s_cselect_b32 s63, s64, s63
  s_lshl_b32 s64, s37, 9
  s_add_u32 s64, s64, 1277952
  s_cmp_eq_u32 s36, 3
  s_cselect_b32 s63, s64, s63
  s_cmp_eq_u32 s36, 0
  s_cselect_b32 s66, 7340032, s63
  v_lshlrev_b32 v12, 7, v0
  v_cmp_gt_u32 vcc, 4, v0
  s_nop 1
  v_cndmask_b32 v12, v9, v12, vcc
  s_lshl_b32 s62, s36, 13
  s_add_u32 s62, s62, 131072
  s_waitcnt lgkmcnt(0)
  s_mov_b32 s44, s34
  s_and_b32 s45, s35, 0xffff
  buffer_load_dword v255, v12, s[44:47], s66 offen
  s_sub_u32 s24, s38, 11
  s_cmp_eq_u32 s36, 3
  s_cselect_b32 s24, s24, -1
  s_cmp_ge_u32 s24, 3
  s_cbranch_scc1 L_T_NOV1
  s_lshl3_add_u32 s27, s24, s37
  s_lshl_b32 s27, s27, 2
  s_lshl_b32 s25, s24, 21
  s_mul_i32 s26, s37, 896
  s_add_u32 s25, s25, s26
  s_add_u32 s25, s25, 1015808
  s_add_u32 s26, s25, 8192
  s_load_dword s28, s[34:35], s25 glc
  s_load_dword s28, s[34:35], s26 glc
L_T_NOV1:
  s_add_u32 m0, s69, 0
  s_xor_b32 s6, s68, 0
  buffer_load_dwordx4 v52, s[52:55], s6 offen nt lds
  s_add_u32 m0, s69, 32768
  s_xor_b32 s6, s68, 256
  buffer_load_dwordx4 v52, s[52:55], s6 offen nt lds
  v_and_b32 v12, 7, v1
  v_lshlrev_b32 v12, 5, v12
  v_lshlrev_b32 v13, 10, v1
  v_lshlrev_b32 v14, 8, v1
  v_add_u32 v14, s69, v14
  v_add_u32 v13, 131072, v13
  v_add_u32 v15, 0, v11
  v_xor_b32 v15, v15, v12
  v_add_u32 v24, v14, v15
  v_add_u32 v28, v13, v15
  v_add_u32 v56, 0x10000, v24
  v_add_u32 v15, 64, v11
  v_xor_b32 v15, v15, v12
  v_add_u32 v25, v14, v15
  v_add_u32 v29, v13, v15
  v_add_u32 v57, 0x10000, v25
  v_add_u32 v15, 128, v11
  v_xor_b32 v15, v15, v12
  v_add_u32 v26, v14, v15
  v_add_u32 v30, v13, v15
  v_add_u32 v58, 0x10000, v26
  v_add_u32 v15, 192, v11
  v_xor_b32 v15, v15, v12
  v_add_u32 v27, v14, v15
  v_add_u32 v31, v13, v15
  v_add_u32 v59, 0x10000, v27
  v_lshrrev_b32 v13, 2, v0
  v_and_b32 v15, 7, v13
  v_lshlrev_b32 v13, 8, v13
  v_and_b32 v12, 3, v1
  v_lshl_add_u32 v13, v12, 3, v13
  s_lshl_b32 s65, s36, 1
  v_xor_b32 v15, s65, v15
  v_lshl_add_u32 v32, v15, 5, v13
  v_xor_b32 v15, 1, v15
  v_lshl_add_u32 v33, v15, 5, v13
  v_add_u32 v34, 0x10000, v32
  v_add_u32 v35, 0x10000, v33
  v_xor_b32 v120, 0, v3
  v_xor_b32 v121, 1056, v3
  v_xor_b32 v122, 2112, v3
  v_xor_b32 v123, 3168, v3
  v_xor_b32 v124, 128, v3
  v_xor_b32 v125, 1184, v3
  v_xor_b32 v126, 2240, v3
  v_xor_b32 v127, 3296, v3
  v_add_u32 v15, 11264, v3
  s_lshl_b32 s63, s36, 2
  v_add_u32 v14, s63, v15
  v_mov_b32 v10, v14
  v_mov_b32 v8, v15
  v_lshrrev_b32 v12, 5, v0
  v_and_b32 v13, 1, v0
  v_lshlrev_b32 v13, 1, v13
  v_lshl_add_u32 v12, v12, 2, v13
  v_bfe_u32 v13, v0, 1, 4
  v_and_b32 v14, 7, v13
  v_lshlrev_b32 v14, 3, v14
  v_lshl_add_u32 v13, v13, 6, v14
  v_lshlrev_b32 v14, 5, v12
  v_xor_b32 v13, v13, v14
  v_lshl_add_u32 v13, v12, 10, v13
  v_add_u32 v6, s62, v13
  v_xor_b32 v7, 32, v6
  s_lshl_b32 s65, s72, 15
  s_lshr_b32 s63, s36, 1
  s_lshl_b32 s63, s63, 14
  s_add_u32 s65, s65, s63
  s_and_b32 s63, s36, 1
  s_lshl_b32 s63, s63, 12
  s_add_u32 s65, s65, s63
  s_add_u32 s65, s65, 2097152
  v_add_u32 v40, s65, v3
  s_and_b32 s75, s72, 0x60
  s_add_u32 s75, s75, s72
  s_lshl2_add_u32 s75, s75, s36
  s_lshl_b32 s75, s75, 6
  s_add_u32 s75, s75, 6291456
  v_min_u32 v68, 92, v4
  s_lshr_b32 s65, s72, 3
  s_lshl_b32 s65, s65, 3
  s_add_u32 s65, s65, s72
  s_lshl2_add_u32 s65, s65, s36
  s_lshl_b32 s65, s65, 8
  s_add_u32 s65, s65, 262144
  v_and_b32 v13, 1, v1
  v_lshrrev_b32 v12, 2, v0
  v_lshl_add_u32 v12, v13, 4, v12
  v_lshlrev_b32 v12, 4, v12
  v_add_u32 v47, 131072, v12
  v_and_b32 v12, 0xff, v12
  v_lshl_add_u32 v12, v13, 13, v12
  v_add_u32 v12, s65, v12
  v_and_b32 v13, 2, v1
  v_cmp_eq_u32 vcc, 0, v13
  s_nop 1
  v_cndmask_b32 v41, v9, v12, vcc
  v_bfe_u32 v13, v47, 6, 3
  v_cmp_eq_u32 vcc, s37, v13
  s_nop 1
  v_cndmask_b32 v4, v9, v41, vcc
  v_and_b32 v13, 3, v1
  v_cmp_eq_u32 vcc, 0, v13
  s_nop 1
  v_cndmask_b32 v5, v9, v0, vcc
  v_lshrrev_b32 v12, 1, v2
  v_lshl_add_u32 v12, v12, 4, v1
  v_lshlrev_b32 v12, 4, v12
  s_lshl_b32 s65, s36, 2
  s_add_u32 s65, s65, 131072
  v_add_u32 v42, s65, v12
  v_lshlrev_b32 v12, 4, v1
  v_add_u32 v43, 131072, v12
  v_add_u32 v22, s65, v12
  v_mov_b32 v38, 0x3e0293ee
  s_lshl_b32 s65, s36, 11
  s_add_u32 s65, s65, 132096
  v_add_u32 v44, s65, v3
  v_add_u32 v45, 132096, v3
  s_and_b32 s71, s37, 4
  s_add_u32 s71, s71, s37
  s_lshl_b32 s71, s71, 11
  s_add_u32 s71, s71, 966656
  v_mov_b32 v16, -1
  v_mov_b32 v17, -1
  v_mov_b32 v18, -1
  v_mov_b32 v19, -1
  s_and_b32 s63, s36, 1
  s_mul_i32 s63, s63, 640
  s_add_u32 s71, s71, s63
  s_lshr_b32 s63, s36, 1
  s_lshl_b32 s63, s63, 13
  s_add_u32 s71, s71, s63
  s_and_b32 s63, s38, 1
  s_lshl_b32 s63, s63, 20
  s_add_u32 s71, s71, s63
  s_cmp_ge_u32 s38, 14
  s_cselect_b32 s63, 40, 0
  v_cmp_gt_u32 vcc, s63, v0
  s_nop 1
  v_cndmask_b32 v20, v9, v3, vcc
  v_lshrrev_b32 v12, 3, v0
  v_lshrrev_b32 v13, 1, v12
  v_and_b32 v14, 1, v12
  v_lshl_add_u32 v13, v14, 4, v13
  v_mul_u32_u24 v13, 1280, v13
  v_and_b32 v14, 7, v0
  v_lshlrev_b32 v14, 4, v14
  v_and_b32 v12, 1, v2
  v_lshlrev_b32 v12, 5, v12
  v_xor_b32 v14, v14, v12
  v_add_u32 v36, v13, v14
  v_xor_b32 v14, 64, v14
  v_add_u32 v37, v13, v14
  s_lshl_b32 s73, s37, 2
  s_add_u32 s73, s73, s36
  s_mul_i32 s73, s73, 163840
  v_mov_b32 v60, 12288
  s_mov_b32 s61, s38
  s_lshl_b32 s74, s36, 14
  s_load_dword s39, s[34:35], 0
  s_add_u32 m0, s69, 1024
  s_xor_b32 s6, s68, 4096
  buffer_load_dwordx4 v53, s[52:55], s6 offen nt lds
  s_add_u32 m0, s69, 33792
  s_xor_b32 s6, s68, 4352
  buffer_load_dwordx4 v53, s[52:55], s6 offen nt lds
  s_add_u32 m0, s69, 2048
  s_xor_b32 s6, s68, 8192
  buffer_load_dwordx4 v52, s[52:55], s6 offen nt lds
  s_add_u32 m0, s69, 34816
  s_xor_b32 s6, s68, 8448
  buffer_load_dwordx4 v52, s[52:55], s6 offen nt lds
  s_cmp_ge_u32 s24, 3
  s_cbranch_scc1 L_T_NOV2
  s_mov_b32 s29, 0
  s_waitcnt lgkmcnt(0)
  s_memtime s[8:9]
  s_waitcnt lgkmcnt(0)
  s_load_dword s28, s[34:35], s25 glc
  s_waitcnt lgkmcnt(0)
  s_memtime s[12:13]
  s_waitcnt lgkmcnt(0)
  s_load_dword s28, s[34:35], s26 glc
  s_waitcnt lgkmcnt(0)
  s_sub_u32 s30, s12, s8
  s_memtime s[8:9]
  s_waitcnt lgkmcnt(0)
  s_sub_u32 s31, s8, s12
  s_sub_u32 s31, s31, s30
  s_max_i32 s31, s31, -300
  s_min_i32 s31, s31, 300
  s_add_u32 s29, s29, s31
  s_getreg_b32 s31, hwreg(HW_REG_XCC_ID, 2, 1)
  s_sub_u32 s30, 0x1000000, s29
  s_cmp_eq_u32 s31, 0
  s_cselect_b32 s29, s29, s30
  s_add_u32 s29, s29, 65536
  s_atomic_add s29, s[32:33], s27
L_T_NOV2:
  s_add_u32 m0, s69, 3072
  s_xor_b32 s6, s68, 12288
  buffer_load_dwordx4 v53, s[52:55], s6 offen nt lds
  s_add_u32 m0, s69, 35840
  s_xor_b32 s6, s68, 12544
  buffer_load_dwordx4 v53, s[52:55], s6 offen nt lds
  s_add_u32 m0, s69, 4096
  s_xor_b32 s6, s68, 16384
  buffer_load_dwordx4 v52, s[52:55], s6 offen nt lds
  s_add_u32 m0, s69, 36864
  s_xor_b32 s6, s68, 16640
  buffer_load_dwordx4 v52, s[52:55], s6 offen nt lds
  s_add_u32 m0, s69, 5120
  s_xor_b32 s6, s68, 20480
  buffer_load_dwordx4 v53, s[52:55], s6 offen nt lds
  s_add_u32 m0, s69, 37888
  s_xor_b32 s6, s68, 20736
  buffer_load_dwordx4 v53, s[52:55], s6 offen nt lds
  s_add_u32 m0, s69, 6144
  s_xor_b32 s6, s68, 24576
  buffer_load_dwordx4 v52, s[52:55], s6 offen nt lds
  s_add_u32 m0, s69, 38912
  s_xor_b32 s6, s68, 24832
  buffer_load_dwordx4 v52, s[52:55], s6 offen nt lds
  s_add_u32 m0, s69, 7168
  s_xor_b32 s6, s68, 28672
  buffer_load_dwordx4 v53, s[52:55], s6 offen nt lds
  s_add_u32 m0, s69, 39936
  s_xor_b32 s6, s68, 28928
  buffer_load_dwordx4 v53, s[52:55], s6 offen nt lds
  s_add_u32 m0, s69, 65536
  s_xor_b32 s6, s68, 512
  buffer_load_dwordx4 v52, s[52:55], s6 offen nt lds
  s_add_u32 m0, s69, 98304
  s_xor_b32 s6, s68, 768
  buffer_load_dwordx4 v52, s[52:55], s6 offen nt lds
  s_add_u32 m0, s69, 66560
  s_xor_b32 s6, s68, 4608
  buffer_load_dwordx4 v53, s[52:55], s6 offen nt lds
  s_add_u32 m0, s69, 99328
  s_xor_b32 s6, s68, 4864
  buffer_load_dwordx4 v53, s[52:55], s6 offen nt lds
  s_add_u32 m0, s69, 67584
  s_xor_b32 s6, s68, 8704
  buffer_load_dwordx4 v52, s[52:55], s6 offen nt lds
  s_add_u32 m0, s69, 100352
  s_xor_b32 s6, s68, 8960
  buffer_load_dwordx4 v52, s[52:55], s6 offen nt lds
  s_add_u32 m0, s69, 68608
  s_xor_b32 s6, s68, 12800
  buffer_load_dwordx4 v53, s[52:55], s6 offen nt lds
  s_add_u32 m0, s69, 101376
  s_xor_b32 s6, s68, 13056
  buffer_load_dwordx4 v53, s[52:55], s6 offen nt lds
  s_add_u32 m0, s69, 69632
  s_xor_b32 s6, s68, 16896
  buffer_load_dwordx4 v52, s[52:55], s6 offen nt lds
  s_add_u32 m0, s69, 102400
  s_xor_b32 s6, s68, 17152
  buffer_load_dwordx4 v52, s[52:55], s6 offen nt lds
  s_add_u32 m0, s69, 70656
  s_xor_b32 s6, s68, 20992
  buffer_load_dwordx4 v53, s[52:55], s6 offen nt lds
  s_add_u32 m0, s69, 103424
  s_xor_b32 s6, s68, 21248
  buffer_load_dwordx4 v53, s[52:55], s6 offen nt lds
  s_waitcnt vmcnt(12)
  ds_read_b128 a[0:3], v24 offset:0
  ds_read_b128 a[4:7], v24 offset:4096
  ds_read_b128 a[8:11], v25 offset:0
  ds_read_b128 a[12:15], v25 offset:4096
  ds_read_b128 a[16:19], v26 offset:0
  ds_read_b128 a[20:23], v26 offset:4096
  ds_read_b128 a[24:27], v27 offset:0
  ds_read_b128 a[28:31], v27 offset:4096
  ds_read_b128 a[32:35], v24 offset:32768
  ds_read_b128 a[36:39], v24 offset:36864
  ds_read_b128 a[40:43], v25 offset:32768
  ds_read_b128 a[44:47], v25 offset:36864
  ds_read_b128 a[48:51], v26 offset:32768
  ds_read_b128 a[52:55], v26 offset:36864
  ds_read_b128 a[56:59], v27 offset:32768
  ds_read_b128 a[60:63], v27 offset:36864
  s_barrier
  ds_read_b64_tr_b16 a[128:129], v32 offset:0
  ds_read_b64_tr_b16 a[130:131], v32 offset:4096
  ds_read_b64_tr_b16 a[132:133], v33 offset:0
  ds_read_b64_tr_b16 a[134:135], v33 offset:4096
  ds_read_b64_tr_b16 a[160:161], v32 offset:8192
  ds_read_b64_tr_b16 a[162:163], v32 offset:12288
  ds_read_b64_tr_b16 a[164:165], v33 offset:8192
  ds_read_b64_tr_b16 a[166:167], v33 offset:12288
  ds_read_b64_tr_b16 a[192:193], v32 offset:16384
  ds_read_b64_tr_b16 a[194:195], v32 offset:20480
  ds_read_b64_tr_b16 a[196:197], v33 offset:16384
  ds_read_b64_tr_b16 a[198:199], v33 offset:20480
  ds_read_b64_tr_b16 a[224:225], v32 offset:24576
  ds_read_b64_tr_b16 a[226:227], v32 offset:28672
  ds_read_b64_tr_b16 a[228:229], v33 offset:24576
  ds_read_b64_tr_b16 a[230:231], v33 offset:28672
  ds_read_b64_tr_b16 a[136:137], v32 offset:32768
  ds_read_b64_tr_b16 a[138:139], v32 offset:36864
  ds_read_b64_tr_b16 a[140:141], v33 offset:32768
  ds_read_b64_tr_b16 a[142:143], v33 offset:36864
  ds_read_b64_tr_b16 a[168:169], v32 offset:40960
  ds_read_b64_tr_b16 a[170:171], v32 offset:45056
  ds_read_b64_tr_b16 a[172:173], v33 offset:40960
  ds_read_b64_tr_b16 a[174:175], v33 offset:45056
  ds_read_b64_tr_b16 a[200:201], v32 offset:49152
  ds_read_b64_tr_b16 a[202:203], v32 offset:53248
  ds_read_b64_tr_b16 a[204:205], v33 offset:49152
  ds_read_b64_tr_b16 a[206:207], v33 offset:53248
  ds_read_b64_tr_b16 a[232:233], v32 offset:57344
  ds_read_b64_tr_b16 a[234:235], v32 offset:61440
  ds_read_b64_tr_b16 a[236:237], v33 offset:57344
  ds_read_b64_tr_b16 a[238:239], v33 offset:61440
  s_add_u32 m0, s69, 71680
  s_xor_b32 s6, s68, 25088
  buffer_load_dwordx4 v52, s[52:55], s6 offen nt lds
  s_add_u32 m0, s69, 104448
  s_xor_b32 s6, s68, 25344
  buffer_load_dwordx4 v52, s[52:55], s6 offen nt lds
  s_add_u32 m0, s69, 72704
  s_xor_b32 s6, s68, 29184
  buffer_load_dwordx4 v53, s[52:55], s6 offen nt lds
  s_waitcnt lgkmcnt(0)
  s_add_u32 s40, s39, 0x9e3779b9
  s_xor_b32 s41, s40, 0x5bd1e995
  s_and_b32 s60, s69, 8192
  s_lshl_b32 s76, s36, 14
  s_add_u32 s76, s76, 163840
  s_add_u32 s77, s76, 4096
  s_lshl_b32 s63, s36, 1
  s_cmp_eq_u32 s63, s37
  s_cselect_b32 s64, s5, s60
  s_add_u32 s76, s76, s64
  v_mov_b32 v12, s64
  s_add_u32 s63, s63, 1
  s_cmp_eq_u32 s63, s37
  s_cselect_b32 s64, s5, s60
  s_add_u32 s77, s77, s64
  v_mov_b32 v13, s64
  v_cmp_gt_u32 vcc, 32, v0
  s_nop 1
  v_cndmask_b32 v12, v13, v12, vcc
  s_lshl_b32 s63, s36, 10
  s_add_u32 s63, s63, 229376
  v_add3_u32 v46, s63, v3, v12
  s_lshl_b32 s79, s72, 7
  s_add_u32 s79, s79, 8192
  s_cmp_eq_u32 s36, 0
  s_cselect_b32 s79, s79, 2147483632
  v_mov_b32 v39, s79
  v_mov_b32 v21, s41
  buffer_store_dword v21, v39, s[44:47], 0 offen
  s_add_u32 m0, s69, 105472
  s_xor_b32 s6, s68, 29440
  buffer_load_dwordx4 v53, s[52:55], s6 offen nt lds
  global_load_dword v69, v68, s[32:33] sc1
  buffer_load_dwordx4 v[80:83], v46, s[44:47], 0 offen sc1
  s_add_u32 m0, s62, 0
  s_nop 0
  buffer_load_dwordx4 v120, s[44:47], s76 offen sc1 lds
  s_add_u32 m0, s62, 1024
  s_nop 0
  buffer_load_dwordx4 v121, s[44:47], s76 offen sc1 lds
  s_add_u32 m0, s62, 2048
  s_nop 0
  buffer_load_dwordx4 v122, s[44:47], s76 offen sc1 lds
  s_add_u32 m0, s62, 3072
  s_nop 0
  buffer_load_dwordx4 v123, s[44:47], s76 offen sc1 lds
  s_add_u32 m0, s62, 4096
  s_nop 0
  buffer_load_dwordx4 v124, s[44:47], s77 offen sc1 lds
  s_add_u32 m0, s62, 5120
  s_nop 0
  buffer_load_dwordx4 v125, s[44:47], s77 offen sc1 lds
  s_add_u32 m0, s62, 6144
  s_nop 0
  buffer_load_dwordx4 v126, s[44:47], s77 offen sc1 lds
  s_add_u32 m0, s62, 7168
  s_nop 0
  buffer_load_dwordx4 v127, s[44:47], s77 offen sc1 lds
  s_waitcnt vmcnt(19)
  ds_read_b128 a[64:67], v56 offset:0
  ds_read_b128 a[72:75], v57 offset:0
  ds_read_b128 a[80:83], v58 offset:0
  ds_read_b128 a[88:91], v59 offset:0
  ds_read_b128 a[96:99], v56 offset:32768
  ds_read_b128 a[104:107], v57 offset:32768
  ds_read_b128 a[112:115], v58 offset:32768
  ds_read_b128 a[120:123], v59 offset:32768
  s_barrier
  ds_read_b64_tr_b16 a[144:145], v34 offset:0
  ds_read_b64_tr_b16 a[148:149], v35 offset:0
  ds_read_b64_tr_b16 a[176:177], v34 offset:8192
  ds_read_b64_tr_b16 a[180:181], v35 offset:8192
  ds_read_b64_tr_b16 a[208:209], v34 offset:16384
  ds_read_b64_tr_b16 a[212:213], v35 offset:16384
  ds_read_b64_tr_b16 a[240:241], v34 offset:24576
  ds_read_b64_tr_b16 a[244:245], v35 offset:24576
  ds_read_b64_tr_b16 a[152:153], v34 offset:32768
  ds_read_b64_tr_b16 a[156:157], v35 offset:32768
  ds_read_b64_tr_b16 a[184:185], v34 offset:40960
  ds_read_b64_tr_b16 a[188:189], v35 offset:40960
  ds_read_b64_tr_b16 a[216:217], v34 offset:49152
  ds_read_b64_tr_b16 a[220:221], v35 offset:49152
  ds_read_b64_tr_b16 a[248:249], v34 offset:57344
  ds_read_b64_tr_b16 a[252:253], v35 offset:57344
  s_branch L_T2
L_T_Q0:
  s_sub_u32 s42, s42, 1
  s_cmp_eq_u32 s42, 0
  s_cbranch_scc1 L_END
  s_add_u32 s4, s4, 1
  s_cmp_ge_u32 s4, 96
  s_cselect_b32 s3, 4293918719, s3
  v_and_b32 v46, s3, v46
  s_and_b32 s76, s76, s3
  s_and_b32 s77, s77, s3
  global_load_dword v69, v68, s[32:33] sc1
  buffer_load_dwordx4 v[80:83], v46, s[44:47], 0 offen sc1
  s_add_u32 m0, s62, 0
  s_nop 0
  buffer_load_dwordx4 v120, s[44:47], s76 offen sc1 lds
  s_add_u32 m0, s62, 1024
  s_nop 0
  buffer_load_dwordx4 v121, s[44:47], s76 offen sc1 lds
  s_add_u32 m0, s62, 2048
  s_nop 0
  buffer_load_dwordx4 v122, s[44:47], s76 offen sc1 lds
  s_add_u32 m0, s62, 3072
  s_nop 0
  buffer_load_dwordx4 v123, s[44:47], s76 offen sc1 lds
  s_add_u32 m0, s62, 4096
  s_nop 0
  buffer_load_dwordx4 v124, s[44:47], s77 offen sc1 lds
  s_add_u32 m0, s62, 5120
  s_nop 0
  buffer_load_dwordx4 v125, s[44:47], s77 offen sc1 lds
  s_add_u32 m0, s62, 6144
  s_nop 0
  buffer_load_dwordx4 v126, s[44:47], s77 offen sc1 lds
  s_add_u32 m0, s62, 7168
  s_nop 0
  buffer_load_dwordx4 v127, s[44:47], s77 offen sc1 lds
  s_branch L_T_Q1
L_T_Q2:
  s_mov_b64 s[12:13], vcc
  s_sub_u32 s42, s42, 1
  s_cmp_eq_u32 s42, 0
  s_cbranch_scc1 L_END
  s_add_u32 s4, s4, 1
  s_cmp_ge_u32 s4, 96
  s_cselect_b32 s3, 4293918719, s3
  v_and_b32 v46, s3, v46
  s_and_b32 s76, s76, s3
  s_and_b32 s77, s77, s3
  buffer_load_dwordx4 v[80:83], v46, s[44:47], 0 offen sc1
  s_cmp_eq_u32 s12, 0
  s_cbranch_scc1 L_T_Q20
  s_add_u32 m0, s62, 0
  s_nop 0
  buffer_load_dwordx4 v120, s[44:47], s76 offen sc1 lds
  s_add_u32 m0, s62, 1024
  s_nop 0
  buffer_load_dwordx4 v121, s[44:47], s76 offen sc1 lds
  s_add_u32 m0, s62, 2048
  s_nop 0
  buffer_load_dwordx4 v122, s[44:47], s76 offen sc1 lds
  s_add_u32 m0, s62, 3072
  s_nop 0
  buffer_load_dwordx4 v123, s[44:47], s76 offen sc1 lds
L_T_Q20:
  s_cmp_eq_u32 s13, 0
  s_cbranch_scc1 L_T_Q21
  s_add_u32 m0, s62, 4096
  s_nop 0
  buffer_load_dwordx4 v124, s[44:47], s77 offen sc1 lds
  s_add_u32 m0, s62, 5120
  s_nop 0
  buffer_load_dwordx4 v125, s[44:47], s77 offen sc1 lds
  s_add_u32 m0, s62, 6144
  s_nop 0
  buffer_load_dwordx4 v126, s[44:47], s77 offen sc1 lds
  s_add_u32 m0, s62, 7168
  s_nop 0
  buffer_load_dwordx4 v127, s[44:47], s77 offen sc1 lds
L_T_Q21:
  s_branch L_T_Q3
L_A2:
  s_getpc_b64 s[20:21]
L_PC:
  s_sub_u32 s20, s20, L_PC-sequential_preLN__compressed_kv_cla__dense_activation_squared_relu__decode_kernel
  s_subb_u32 s21, s21, 0
  s_lshl_b32 s63, s36, 13
  v_lshlrev_b32 v12, 7, v0
  v_add_u32 v12, s63, v12
  v_min_u32 v12, L_CODE_END-4-sequential_preLN__compressed_kv_cla__dense_activation_squared_relu__decode_kernel, v12
  s_and_b32 s63, s72, 3
  s_cmp_lg_u32 s63, 0
  s_cbranch_scc1 L_NOPF
  global_load_dword v255, v12, s[20:21]
L_NOPF:
  s_barrier
  v_lshrrev_b32 v12, 1, v2
  v_lshl_add_u32 v62, v12, 20, v5
  v_and_b32 v12, 1, v2
  v_lshl_add_u32 v62, v12, 17, v62
  v_xor_b32 v62, s67, v62
  s_lshl_b32 s61, s74, 3
  s_add_u32 s61, s61, s37
  s_and_b32 s60, s72, 3
  s_lshl_b32 s65, s61, 2
  s_add_u32 s60, s60, s65
  v_and_b32 v5, 7, v1
  v_lshlrev_b32 v5, 4, v5
  v_and_b32 v6, 1, v2
  v_lshl_add_u32 v6, v6, 3, v5
  v_lshrrev_b32 v12, 3, v0
  v_and_b32 v13, 3, v12
  v_lshl_add_u32 v14, v13, 11, v5
  v_lshrrev_b32 v13, 5, v0
  v_lshl_add_u32 v14, v13, 14, v14
  v_cmp_eq_u32 vcc, s37, v12
  v_or_b32 v13, s5, v14
  s_lshr_b32 s77, s37, 2
  s_lshl_b32 s77, s77, 13
  v_cndmask_b32 v46, v14, v13, vcc
  v_mov_b32 v15, 8192
  v_cndmask_b32 v40, v15, 0, vcc
  s_cmp_ge_u32 s61, 27
  s_cbranch_scc1 L_A_NOF
  s_lshl_b32 s63, s60, 5
  s_add_u32 s48, s22, s63
  s_addc_u32 s49, s23, 0
  s_and_b32 s49, s49, 0xffff
  s_sub_u32 s50, 2211840, s63
  s_mov_b32 s51, 0x20000
  s_mul_i32 s63, s60, 20480
  s_add_u32 s52, s26, s63
  s_addc_u32 s53, s27, 0
  s_and_b32 s53, s53, 0xffff
  s_sub_u32 s54, 2211840, s63
  s_mov_b32 s55, 0x20000
  v_and_b32 v7, 3, v12
  v_lshlrev_b32 v7, 3, v7
  v_lshrrev_b32 v8, 5, v0
  v_lshl_add_u32 v7, v8, 2, v7
  v_bfe_u32 v8, v0, 1, 2
  v_add_u32 v7, v7, v8
  v_mul_u32_u24 v7, 3456, v7
  v_and_b32 v8, 1, v0
  v_lshl_add_u32 v7, v8, 4, v7
  s_and_b32 s78, s60, 3
  s_lshl_b32 s78, s78, 2
  s_add_u32 s78, s78, s36
  s_mov_b32 s6, s78
  s_lshl_b32 s63, s6, 10
  s_add_u32 m0, s63, 69632
  s_mul_i32 s63, s6, 110592
  buffer_load_dwordx4 v7, s[48:51], s63 offen  lds
  s_add_u32 s6, s36, 16
  s_lshl_b32 s63, s6, 10
  s_add_u32 m0, s63, 69632
  s_mul_i32 s63, s6, 110592
  buffer_load_dwordx4 v7, s[48:51], s63 offen  lds
  s_mul_i32 s62, s36, 3
  s_cmp_eq_u32 s36, 3
  s_cselect_b32 s62, 8, s62
  s_lshl_b32 s62, s62, 7
  v_lshrrev_b32 v8, 1, v2
  v_lshl_add_u32 v8, v8, 7, v6
  s_cmp_lt_u32 s36, 2
  s_cselect_b32 s63, 32, 0
  v_cmp_gt_u32 vcc, s63, v0
  s_nop 1
  v_cndmask_b32 v13, v9, v6, vcc
  v_cmp_gt_u32 vcc, 8, v1
  s_nop 1
  v_cndmask_b32 v12, v9, v8, vcc
  v_cndmask_b32 v13, v9, v13, vcc
  buffer_load_dwordx2 v[16:17], v12, s[56:59], s62 offen
  buffer_load_dwordx2 v[18:19], v13, s[56:59], s62 offen offset:256
  s_lshl_b32 s63, s60, 5
  s_add_u32 s56, s24, s63
  s_addc_u32 s57, s25, 0
  s_and_b32 s57, s57, 0xffff
  s_sub_u32 s58, 3456, s63
  s_mov_b32 s59, 0x20000
  v_lshlrev_b32 v12, 3, v2
  buffer_load_dwordx2 v[58:59], v12, s[56:59], 0 offen
  s_lshl_b32 s63, s36, 9
  s_add_u32 s63, s63, 4096
  v_add_u32 v48, s63, v8
  v_add_u32 v12, 256, v48
  v_mov_b32 v13, 3584
  v_cmp_gt_u32 vcc, 32, v0
  s_nop 1
  v_cndmask_b32 v49, v13, v12, vcc
  v_add_u32 v50, s63, v11
  s_cmp_lt_u32 s36, 2
  s_cselect_b32 s63, 0, 2147483632
  v_max_u32 v47, s63, v46
  s_add_u32 s79, s62, 966656
  v_lshl_add_u32 v12, v1, 6, v11
  s_mul_i32 s63, s36, 320
  v_add_u32 v13, s63, v12
  s_and_b32 s65, s60, 3
  s_lshl3_add_u32 s65, s61, s65
  s_lshl_b32 s65, s65, 11
  s_add_u32 s65, s65, 532480
  v_add_u32 v12, s65, v13
  v_cmp_gt_u32 vcc, 5, v1
  s_nop 1
  v_cndmask_b32 v51, v9, v12, vcc
  v_bfe_u32 v13, v13, 7, 2
  v_add_u32 v13, 4, v13
  v_cmp_eq_u32 vcc, s37, v13
  s_nop 1
  v_cndmask_b32 v43, v9, v51, vcc
  s_and_b32 s63, s36, 1
  s_mul_i32 s63, s63, 640
  s_add_u32 s65, s65, s63
  s_lshr_b32 s63, s36, 1
  s_lshl_b32 s63, s63, 20
  s_add_u32 s65, s65, s63
  v_add_u32 v12, s65, v3
  v_cmp_gt_u32 vcc, 40, v0
  s_nop 1
  v_cndmask_b32 v41, v9, v12, vcc
  s_lshl_b32 s65, s62, 4
  s_add_u32 s65, s65, 69632
  v_lshlrev_b32 v52, 3, v0
  v_add_u32 v52, s65, v52
  v_lshrrev_b32 v12, 2, v0
  v_mul_u32_u24 v12, 1280, v12
  v_and_b32 v13, 3, v1
  v_lshl_add_u32 v12, v13, 4, v12
  v_add_u32 v53, 90112, v12
  s_lshl_b32 s63, s36, 2
  v_lshrrev_b32 v12, 5, v0
  v_lshlrev_b32 v12, 4, v12
  v_add_u32 v12, s63, v12
  v_add_u32 v54, 6400, v12
  s_lshl_b32 s63, s36, 6
  v_add_u32 v55, 6144, v11
  v_add_u32 v45, s63, v55
  v_mov_b32 v44, 6400
  s_cmp_eq_u32 s36, 3
  s_cselect_b32 s63, 2048, 0
  v_subrev_u32 v42, s63, v52
  v_lshrrev_b32 v12, 2, v1
  v_lshlrev_b32 v12, 6, v12
  s_mul_i32 s63, s36, 320
  v_xor_b32 v13, s63, v12
  v_add_u32 v229, v13, v53
  s_add_u32 s63, s63, 64
  v_xor_b32 v13, s63, v12
  v_add_u32 v230, v13, v53
  s_add_u32 s63, s63, 64
  v_xor_b32 v13, s63, v12
  v_add_u32 v231, v13, v53
  s_add_u32 s63, s63, 64
  v_xor_b32 v13, s63, v12
  v_add_u32 v232, v13, v53
  s_add_u32 s63, s63, 64
  v_xor_b32 v13, s63, v12
  v_add_u32 v233, v13, v53
  s_branch L_A_FDONE
L_A_NOF:
  s_and_b32 s63, s72, 3
  s_and_b32 s60, s37, 3
  s_lshl2_add_u32 s60, s63, s60
  s_cmp_lt_u32 s37, 4
  s_cselect_b32 s60, 15, s60
  s_lshl_b32 s62, s60, 7
  s_mov_b32 s52, s28
  s_and_b32 s53, s29, 0xffff
  s_mov_b32 s54, 1280
  s_mov_b32 s55, 0x20000
  s_cmp_eq_u32 s36, 0
  s_cselect_b32 s64, 32, 0
  v_cmp_gt_u32 vcc, s64, v0
  s_nop 1
  v_cndmask_b32 v6, v9, v6, vcc
  v_cmp_gt_u32 vcc, 8, v1
  s_nop 1
  v_cndmask_b32 v6, v9, v6, vcc
  buffer_load_dwordx2 v[16:17], v6, s[56:59], s62 offen
  buffer_load_dwordx2 v[18:19], v6, s[52:55], s62 offen
  s_mul_i32 s63, s36, 28
  v_add_u32 v15, s63, v12
  v_bfe_u32 v10, v15, 2, 3
  v_cmp_eq_u32 vcc, s37, v10
  s_nop 1
  v_cndmask_b32 v48, v14, v13, vcc
  v_add_u32 v15, 8, v15
  v_bfe_u32 v10, v15, 2, 3
  v_cmp_eq_u32 vcc, s37, v10
  s_nop 1
  v_cndmask_b32 v49, v14, v13, vcc
  v_add_u32 v15, 8, v15
  v_add_u32 v49, 32768, v49
  v_bfe_u32 v10, v15, 2, 3
  v_cmp_eq_u32 vcc, s37, v10
  s_nop 1
  v_cndmask_b32 v50, v14, v13, vcc
  v_add_u32 v15, 8, v15
  v_add_u32 v50, 65536, v50
  v_bfe_u32 v10, v15, 2, 3
  v_cmp_eq_u32 vcc, s37, v10
  s_nop 1
  v_cndmask_b32 v51, v14, v13, vcc
  v_add_u32 v51, 98304, v51
  s_cmp_lt_u32 s36, 3
  s_cselect_b32 s64, 4, 0
  v_cmp_gt_u32 vcc, s64, v12
  s_nop 1
  v_cndmask_b32 v51, v9, v51, vcc
  s_add_u32 s79, s62, 966656
  v_mov_b32 v47, v46
  v_mov_b32 v43, v9
  v_mov_b32 v41, v9
  s_lshl_b32 s63, s63, 12
  s_add_u32 s78, s62, s63
  s_add_u32 s78, s78, 532480
  v_lshlrev_b32 v52, 5, v1
  v_lshl_add_u32 v52, v2, 4, v52
  s_lshl_b32 s64, s36, 8
  s_add_u32 s64, s64, 2560
  v_add_u32 v52, s64, v52
  v_mov_b32 v13, 3584
  v_cmp_gt_u32 vcc, 32, v0
  s_nop 1
  v_cndmask_b32 v52, v13, v52, vcc
  v_cmp_gt_u32 vcc, 8, v1
  s_nop 1
  v_cndmask_b32 v52, v13, v52, vcc
  v_cmp_gt_u32 vcc, 16, v0
  v_lshlrev_b32 v12, 3, v0
  s_nop 0
  v_cndmask_b32 v53, v9, v12, vcc
  v_lshlrev_b32 v54, 4, v1
  v_cmp_eq_u32 vcc, 0, v0
  s_nop 1
  v_cndmask_b32 v55, v9, v0, vcc
L_A_FDONE:
  s_lshl_b32 s63, s36, 2
  v_add_u32 v12, s63, v2
  v_add_u32 v13, 0, v12
  v_mul_u32_u24 v13, 205, v13
  v_bfe_u32 v13, v13, 10, 2
  v_lshlrev_b32 v13, 6, v13
  v_xor_b32 v224, v13, v3
  v_add_u32 v13, 16, v12
  v_mul_u32_u24 v13, 205, v13
  v_bfe_u32 v13, v13, 10, 2
  v_lshlrev_b32 v13, 6, v13
  v_xor_b32 v225, v13, v3
  v_add_u32 v13, 32, v12
  v_mul_u32_u24 v13, 205, v13
  v_bfe_u32 v13, v13, 10, 2
  v_lshlrev_b32 v13, 6, v13
  v_xor_b32 v226, v13, v3
  v_add_u32 v13, 48, v12
  v_mul_u32_u24 v13, 205, v13
  v_bfe_u32 v13, v13, 10, 2
  v_lshlrev_b32 v13, 6, v13
  v_xor_b32 v227, v13, v3
  v_add_u32 v13, 64, v12
  v_mul_u32_u24 v13, 205, v13
  v_bfe_u32 v13, v13, 10, 2
  v_lshlrev_b32 v13, 6, v13
  v_xor_b32 v228, v13, v3
  v_and_b32 v12, 1, v1
  v_cmp_eq_u32 vcc, 1, v12
  v_mov_b32 v12, 65535
  v_mov_b32 v13, 4294901760
  v_cndmask_b32 v12, v12, v13, vcc
  v_lshrrev_b32 v13, 1, v1
  v_cmp_eq_u32 vcc, 0, v13
  s_nop 1
  v_cndmask_b32 v36, 0, v12, vcc
  v_cmp_eq_u32 vcc, 1, v13
  s_nop 1
  v_cndmask_b32 v37, 0, v12, vcc
  v_cmp_eq_u32 vcc, 2, v13
  s_nop 1
  v_cndmask_b32 v38, 0, v12, vcc
  v_cmp_eq_u32 vcc, 3, v13
  s_nop 1
  v_cndmask_b32 v39, 0, v12, vcc
  s_lshl_b32 s63, s36, 2
  v_add_u32 v12, s63, v2
  v_lshlrev_b32 v20, 10, v1
  v_lshl_add_u32 v20, v12, 14, v20
  v_lshrrev_b32 v13, 1, v12
  v_cmp_eq_u32 vcc, s37, v13
  v_or_b32 v12, s5, v20
  s_nop 0
  v_cndmask_b32 v20, v20, v12, vcc
  v_and_b32 v20, s3, v20
  v_lshl_add_u32 v12, v2, 3, v1
  v_lshlrev_b32 v12, 8, v12
  v_mov_b32 v13, s40
  v_cmp_gt_u32 vcc, 8, v1
  s_nop 1
  v_cndmask_b32 v20, v9, v20, vcc
  v_cndmask_b32 v26, v9, v12, vcc
  v_cndmask_b32 v25, 0, v13, vcc
  s_mov_b32 s70, 0x00ff00ff
  s_mov_b32 s71, 0x00ff00ff
  s_and_b32 s64, s73, 15
  s_lshl4_add_u32 s68, s74, s64
  s_lshl_b32 s67, s68, 2
  s_lshl_b32 s68, s68, 4
  s_add_u32 s68, s68, s77
  s_add_u32 s68, s68, 262144
  s_add_u32 s67, s67, s77
  s_lshl_b32 s64, s36, 14
  s_add_u32 s67, s67, s64
  s_add_u32 s67, s67, 6291456
  v_lshlrev_b32 v22, 18, v2
  v_lshl_add_u32 v22, v1, 4, v22
  s_lshl_b32 s63, s36, 20
  s_add_u32 s69, s77, s63
  s_add_u32 s69, s69, 2097152
  s_lshr_b32 s63, s74, 1
  s_lshl_b32 s63, s63, 14
  s_add_u32 s69, s69, s63
  s_and_b32 s63, s74, 1
  s_lshl_b32 s63, s63, 12
  s_add_u32 s69, s69, s63
  s_and_b32 s63, s73, 3
  s_lshl_b32 s63, s63, 10
  s_add_u32 s69, s69, s63
  s_bfe_u32 s63, s73, 0x20002
  s_lshl_b32 s63, s63, 8
  s_add_u32 s69, s69, s63
  v_lshlrev_b32 v12, 4, v1
  v_lshl_add_u32 v12, v2, 3, v12
  s_mul_i32 s63, s36, 320
  s_add_u32 s63, s63, 1024
  v_add_u32 v12, s63, v12
  v_mov_b32 v13, 3584
  v_cmp_gt_u32 vcc, 32, v0
  s_nop 1
  v_cndmask_b32 v23, v13, v12, vcc
  v_and_b32 v12, 3, v1
  v_mul_u32_u24 v12, 320, v12
  v_add_u32 v12, v12, v11
  v_add_u32 v24, 1024, v12
  s_lshl_b32 s63, s36, 2
  s_add_u32 s63, s63, 2304
  v_mov_b32 v12, s63
  v_cmp_gt_u32 vcc, 8, v1
  s_nop 1
  v_cndmask_b32 v21, v13, v12, vcc
  v_mov_b32 v27, 2304
  v_add_u32 v56, 36864, v60
  v_add_u32 v57, 36864, v61
  s_lshl_b32 s63, s74, 18
  s_lshl_b32 s64, s73, 8
  s_add_u32 s63, s63, s64
  s_add_u32 s56, s16, s63
  s_addc_u32 s57, s17, 0
  s_and_b32 s57, s57, 0xffff
  s_sub_u32 s58, 4194304, s63
  s_mov_b32 s59, 0x20000
  s_cmp_lt_u32 s61, 27
  s_cselect_b32 s9, 1, 0
  s_lshl_b32 s75, s66, 7
  s_add_u32 s75, s75, 8192
  v_mov_b32 v12, 0
  s_mov_b32 s8, 40
L_A_G:
  buffer_load_dword v13, v12, s[44:47], s75 offen sc1
  s_waitcnt vmcnt(0)
  v_readfirstlane_b32 s76, v13
  s_nop 0
  s_cmp_eq_u32 s76, s41
  s_cbranch_scc1 L_A_GOK
  s_cmp_eq_u32 s9, 0
  s_cbranch_scc1 L_A_G2
  s_mov_b32 s9, 0
  s_add_u32 s78, s78, 4
  s_and_b32 s78, s78, 15
  s_mov_b32 s6, s78
  s_lshl_b32 s63, s6, 10
  s_add_u32 m0, s63, 69632
  s_mul_i32 s63, s6, 110592
  buffer_load_dwordx4 v7, s[48:51], s63 offen  lds
  s_add_u32 s78, s78, 4
  s_and_b32 s78, s78, 15
  s_mov_b32 s6, s78
  s_lshl_b32 s63, s6, 10
  s_add_u32 m0, s63, 69632
  s_mul_i32 s63, s6, 110592
  buffer_load_dwordx4 v7, s[48:51], s63 offen  lds
  s_add_u32 s78, s78, 4
  s_and_b32 s78, s78, 15
  s_mov_b32 s6, s78
  s_lshl_b32 s63, s6, 10
  s_add_u32 m0, s63, 69632
  s_mul_i32 s63, s6, 110592
  buffer_load_dwordx4 v7, s[48:51], s63 offen  lds
L_A_G2:
  s_sub_u32 s8, s8, 1
  s_cbranch_scc0 L_A_G
L_A_GOK:
  s_and_b32 s63, s36, 1
  s_lshl_b32 s63, s63, 8
  s_lshr_b32 s64, s36, 1
  s_add_u32 s63, s63, s64
  s_lshl_b32 s63, s63, 13
  s_lshl_b32 s64, s36, 10
  s_add_u32 m0, s64, 36864
  s_nop 0
  buffer_load_dwordx4 v62, s[56:59], s63 offen nt lds
  s_add_u32 s63, s63, 16384
  s_add_u32 m0, s64, 40960
  s_nop 0
  buffer_load_dwordx4 v62, s[56:59], s63 offen nt lds
  s_add_u32 s63, s63, 16384
  s_add_u32 m0, s64, 45056
  s_nop 0
  buffer_load_dwordx4 v62, s[56:59], s63 offen nt lds
  s_add_u32 s63, s63, 16384
  s_add_u32 m0, s64, 49152
  s_nop 0
  buffer_load_dwordx4 v62, s[56:59], s63 offen nt lds
  s_add_u32 s63, s63, 16384
  s_add_u32 m0, s64, 53248
  s_nop 0
  buffer_load_dwordx4 v62, s[56:59], s63 offen nt lds
  s_add_u32 s63, s63, 16384
  s_add_u32 m0, s64, 57344
  s_nop 0
  buffer_load_dwordx4 v62, s[56:59], s63 offen nt lds
  s_add_u32 s63, s63, 16384
  s_add_u32 m0, s64, 61440
  s_nop 0
  buffer_load_dwordx4 v62, s[56:59], s63 offen nt lds
  s_add_u32 s63, s63, 16384
  s_add_u32 m0, s64, 65536
  s_nop 0
  buffer_load_dwordx4 v62, s[56:59], s63 offen nt lds
  s_cmp_eq_u32 s9, 0
  s_cbranch_scc1 L_A_NOW1
  s_add_u32 s78, s78, 4
  s_and_b32 s78, s78, 15
  s_mov_b32 s6, s78
  s_lshl_b32 s63, s6, 10
  s_add_u32 m0, s63, 69632
  s_mul_i32 s63, s6, 110592
  buffer_load_dwordx4 v7, s[48:51], s63 offen  lds
  s_add_u32 s78, s78, 4
  s_and_b32 s78, s78, 15
  s_mov_b32 s6, s78
  s_lshl_b32 s63, s6, 10
  s_add_u32 m0, s63, 69632
  s_mul_i32 s63, s6, 110592
  buffer_load_dwordx4 v7, s[48:51], s63 offen  lds
  s_add_u32 s78, s78, 4
  s_and_b32 s78, s78, 15
  s_mov_b32 s6, s78
  s_lshl_b32 s63, s6, 10
  s_add_u32 m0, s63, 69632
  s_mul_i32 s63, s6, 110592
  buffer_load_dwordx4 v7, s[48:51], s63 offen  lds
L_A_NOW1:
  v_min_u32 v14, 92, v4
  buffer_load_dword v255, v102, s[44:47], s5 offen
L_A_POL:
  global_load_dword v15, v14, s[32:33] sc1
  s_waitcnt vmcnt(0)
  v_cmp_lt_u32 vcc, 0xffffff, v15
  v_and_b32 v15, 0xffffff, v15
  s_and_b32 s11, vcc_lo, 15
  v_cmp_eq_u32 vcc, 0, v15
  v_add_u32_dpp v15, v15, v15 quad_perm:[1,0,3,2] row_mask:0xf bank_mask:0xf
  s_nop 1
  v_add_u32_dpp v15, v15, v15 quad_perm:[2,3,0,1] row_mask:0xf bank_mask:0xf
  s_nop 1
  v_add_u32_dpp v15, v15, v15 row_half_mirror row_mask:0xf bank_mask:0xf
  s_nop 0
  v_readlane_b32 s8, v15, 0
  v_readlane_b32 s9, v15, 8
  v_readlane_b32 s10, v15, 16
  s_sub_u32 s12, s8, s9
  s_add_u32 s12, s12, s10
  s_lshl1_add_u32 s8, s8, s12
  s_lshl1_add_u32 s10, s10, s12
  s_lshl_b32 s9, s9, 1
  s_sub_u32 s9, s9, s12
  s_cmp_lt_u32 s8, 1572864
  s_cselect_b32 s8, 8192, 0
  s_cmp_lt_u32 s9, 524288
  s_cselect_b32 s9, 8192, 0
  s_cmp_lt_u32 s10, 1572864
  s_cselect_b32 s10, 8192, 0
  s_cbranch_vccz L_A_POLOK
  s_sub_u32 s42, s42, 1
  s_cmp_eq_u32 s42, 0
  s_cbranch_scc1 L_END
  s_branch L_A_POL
L_A_POLOK:
  s_and_b32 s12, s37, 3
  s_lshr_b32 s12, s11, s12
  s_and_b32 s12, s12, 1
  s_lshl_b32 s12, s12, 13
  s_xor_b32 s67, s67, s9
  s_xor_b32 s67, s67, s12
  s_cmp_lt_u32 s36, 2
  s_cselect_b32 s9, s9, s10
  s_xor_b32 s9, s9, s12
  s_xor_b32 s12, s12, s8
  s_xor_b32 s69, s69, s9
  s_xor_b32 s68, s68, s12
  s_xor_b32 s77, s77, s12
  v_and_b32 v40, s77, v40
  v_xor_b32 v46, v46, v40
  v_xor_b32 v47, v47, v40
  v_xor_b32 v43, s12, v43
  v_bfe_u32 v12, v41, 7, 2
  v_bfe_u32 v12, s11, v12, 1
  v_lshlrev_b32 v12, 13, v12
  v_xor_b32 v12, s8, v12
  v_xor_b32 v41, v12, v41
  v_bfe_u32 v12, v51, 7, 2
  v_bfe_u32 v12, s11, v12, 1
  v_lshlrev_b32 v12, 13, v12
  v_xor_b32 v12, s8, v12
  s_cmp_ge_u32 s61, 27
  s_cselect_b32 s9, s12, 0
  s_cselect_b32 s10, 0, -1
  s_xor_b32 s78, s78, s9
  v_and_b32 v12, s10, v12
  v_xor_b32 v51, v12, v51
  v_mov_b32 v12, -1
  v_mov_b32 v13, -1
  v_mov_b32 v14, -1
  v_mov_b32 v15, -1
  buffer_store_dwordx4 v[12:15], v41, s[44:47], 0 offen sc1
  s_branch L_A3
L_T3:
  s_cmp_ge_u32 s61, 10
  s_cbranch_scc1 L_END
  s_add_u32 m0, s74, 8192
  s_mov_b32 s6, 81920
  buffer_load_dwordx4 v36, s[48:51], s6 offen nt lds
  s_add_u32 m0, s74, 9216
  s_mov_b32 s6, 87040
  buffer_load_dwordx4 v37, s[48:51], s6 offen nt lds
  s_add_u32 m0, s74, 10240
  s_mov_b32 s6, 92160
  buffer_load_dwordx4 v36, s[48:51], s6 offen nt lds
  s_add_u32 m0, s74, 11264
  s_mov_b32 s6, 97280
  buffer_load_dwordx4 v37, s[48:51], s6 offen nt lds
  s_add_u32 m0, s74, 12288
  s_mov_b32 s6, 122880
  buffer_load_dwordx4 v36, s[48:51], s6 offen nt lds
  s_add_u32 m0, s74, 13312
  s_mov_b32 s6, 128000
  buffer_load_dwordx4 v37, s[48:51], s6 offen nt lds
  s_add_u32 m0, s74, 14336
  s_mov_b32 s6, 133120
  buffer_load_dwordx4 v36, s[48:51], s6 offen nt lds
  s_add_u32 m0, s74, 15360
  s_mov_b32 s6, 138240
  buffer_load_dwordx4 v37, s[48:51], s6 offen nt lds
  v_lshrrev_b32 v12, 2, v1
  v_lshl_add_u32 v12, v2, 3, v12
  v_lshlrev_b32 v12, 7, v12
  v_and_b32 v13, 3, v1
  v_lshl_add_u32 v12, v13, 3, v12
  v_lshrrev_b32 v14, 3, v1
  v_and_b32 v15, 1, v2
  v_lshl_or_b32 v14, v15, 1, v14
  v_xor_b32 v14, s36, v14
  v_lshl_add_u32 v24, v14, 5, v12
  v_mul_u32_u24 v13, 320, v13
  v_add_u32 v13, v13, v11
  v_add_u32 v25, 65536, v13
  v_mul_u32_u24 v12, 320, v2
  v_lshl_add_u32 v12, v1, 3, v12
  s_mul_i32 s63, s36, 1280
  s_add_u32 s63, s63, 65536
  v_add_u32 v26, s63, v12
  v_lshlrev_b32 v12, 4, v1
  v_lshl_add_u32 v27, v2, 11, v12
  s_lshl4_add_u32 s75, s37, s36
  s_lshl_b32 s75, s75, 9
  s_add_u32 s75, s75, 1146880
  s_and_b32 s75, s75, s3
  s_and_b32 s63, s37, 4
  s_add_u32 s63, s63, s37
  s_lshl_b32 s63, s63, 11
  s_lshl_b32 s64, s61, 7
  s_add_u32 s63, s63, s64
  s_lshl_b32 s64, s36, 5
  s_add_u32 s63, s63, s64
  s_add_u32 s63, s63, 966656
  v_lshlrev_b32 v12, 1, v1
  v_lshl_add_u32 v12, v2, 13, v12
  v_add_u32 v12, s63, v12
  v_cmp_gt_u32 vcc, 32, v0
  s_nop 1
  v_cndmask_b32 v28, v9, v12, vcc
  v_cmp_gt_u32 vcc, 16, v0
  s_nop 1
  v_cndmask_b32 v29, v9, v12, vcc
  s_waitcnt vmcnt(0)
  s_barrier
  s_mov_b32 s76, s40
  s_mov_b32 s77, s40
  buffer_load_dwordx4 v[64:67], v27, s[44:47], s75 offen sc1
  buffer_load_dwordx4 v[68:71], v27, s[44:47], s75 offen offset:256 sc1
  ds_read_b64_tr_b16 a[0:1], v24 offset:0
  ds_read_b64_tr_b16 a[2:3], v24 offset:512
  ds_read_b64_tr_b16 a[4:5], v24 offset:4096
  ds_read_b64_tr_b16 a[6:7], v24 offset:4608
  ds_read_b64_tr_b16 a[8:9], v24 offset:8192
  ds_read_b64_tr_b16 a[10:11], v24 offset:8704
  ds_read_b64_tr_b16 a[12:13], v24 offset:12288
  ds_read_b64_tr_b16 a[14:15], v24 offset:12800
  ds_read_b64_tr_b16 a[16:17], v24 offset:16384
  ds_read_b64_tr_b16 a[18:19], v24 offset:16896
  buffer_load_dwordx4 v[72:75], v27, s[44:47], s75 offen sc1
  buffer_load_dwordx4 v[76:79], v27, s[44:47], s75 offen offset:256 sc1
  ds_read_b64_tr_b16 a[20:21], v24 offset:20480
  ds_read_b64_tr_b16 a[22:23], v24 offset:20992
  ds_read_b64_tr_b16 a[24:25], v24 offset:24576
  ds_read_b64_tr_b16 a[26:27], v24 offset:25088
  ds_read_b64_tr_b16 a[28:29], v24 offset:28672
  ds_read_b64_tr_b16 a[30:31], v24 offset:29184
  ds_read_b64_tr_b16 a[32:33], v24 offset:32768
  ds_read_b64_tr_b16 a[34:35], v24 offset:33280
  ds_read_b64_tr_b16 a[36:37], v24 offset:36864
  ds_read_b64_tr_b16 a[38:39], v24 offset:37376
  buffer_load_dwordx4 v[80:83], v27, s[44:47], s75 offen sc1
  buffer_load_dwordx4 v[84:87], v27, s[44:47], s75 offen offset:256 sc1
  ds_read_b64_tr_b16 a[40:41], v24 offset:40960
  ds_read_b64_tr_b16 a[42:43], v24 offset:41472
  ds_read_b64_tr_b16 a[44:45], v24 offset:45056
  ds_read_b64_tr_b16 a[46:47], v24 offset:45568
  ds_read_b64_tr_b16 a[48:49], v24 offset:49152
  ds_read_b64_tr_b16 a[50:51], v24 offset:49664
  ds_read_b64_tr_b16 a[52:53], v24 offset:53248
  ds_read_b64_tr_b16 a[54:55], v24 offset:53760
  ds_read_b64_tr_b16 a[56:57], v24 offset:57344
  ds_read_b64_tr_b16 a[58:59], v24 offset:57856
  ds_read_b64_tr_b16 a[60:61], v24 offset:61440
  ds_read_b64_tr_b16 a[62:63], v24 offset:61952
L_C_HC:
  s_waitcnt vmcnt(4)
  ds_write2_b32 v26, v64, v66 offset0:0 offset1:1
  ds_write2_b32 v26, v68, v70 offset0:32 offset1:33
  v_and_b32 v12, v65, v67
  v_or_b32 v13, v65, v67
  v_bitop3_b32 v12, v12, v69, v71 bitop3:0x80
  v_or3_b32 v13, v13, v69, v71
  v_cmp_ne_u64 vcc, s[76:77], v[12:13]
  s_cbranch_vccz L_C_HC_OK
  buffer_load_dwordx4 v[64:67], v27, s[44:47], s75 offen sc1
  buffer_load_dwordx4 v[68:71], v27, s[44:47], s75 offen offset:256 sc1
  s_waitcnt vmcnt(4)
  ds_write2_b32 v26, v72, v74 offset0:0 offset1:1
  ds_write2_b32 v26, v76, v78 offset0:32 offset1:33
  v_and_b32 v12, v73, v75
  v_or_b32 v13, v73, v75
  v_bitop3_b32 v12, v12, v77, v79 bitop3:0x80
  v_or3_b32 v13, v13, v77, v79
  v_cmp_ne_u64 vcc, s[76:77], v[12:13]
  s_cbranch_vccz L_C_HC_OK
  buffer_load_dwordx4 v[72:75], v27, s[44:47], s75 offen sc1
  buffer_load_dwordx4 v[76:79], v27, s[44:47], s75 offen offset:256 sc1
  s_waitcnt vmcnt(4)
  ds_write2_b32 v26, v80, v82 offset0:0 offset1:1
  ds_write2_b32 v26, v84, v86 offset0:32 offset1:33
  v_and_b32 v12, v81, v83
  v_or_b32 v13, v81, v83
  v_bitop3_b32 v12, v12, v85, v87 bitop3:0x80
  v_or3_b32 v13, v13, v85, v87
  v_cmp_ne_u64 vcc, s[76:77], v[12:13]
  s_cbranch_vccz L_C_HC_OK
  s_sub_u32 s42, s42, 1
  s_cmp_eq_u32 s42, 0
  s_cbranch_scc1 L_END
  s_add_u32 s4, s4, 1
  s_cmp_ge_u32 s4, 96
  s_cselect_b32 s3, 4293918719, s3
  s_and_b32 s75, s75, s3
  buffer_load_dwordx4 v[80:83], v27, s[44:47], s75 offen sc1
  buffer_load_dwordx4 v[84:87], v27, s[44:47], s75 offen offset:256 sc1
  s_branch L_C_HC
L_C_HC_OK:
  s_waitcnt lgkmcnt(0)
  s_barrier
  ds_read_b128 v[128:131], v25 offset:0
  ds_read_b128 v[132:135], v25 offset:64
  ds_read_b128 v[136:139], v25 offset:128
  ds_read_b128 v[140:143], v25 offset:192
  ds_read_b128 v[144:147], v25 offset:1280
  ds_read_b128 v[148:151], v25 offset:1344
  ds_read_b128 v[152:155], v25 offset:1408
  ds_read_b128 v[156:159], v25 offset:1472
  s_waitcnt lgkmcnt(7)
  v_mfma_f32_16x16x32_bf16 v[104:107], v[128:131], a[0:3], 0
  ds_read_b128 v[160:163], v25 offset:2560
  s_waitcnt lgkmcnt(7)
  v_mfma_f32_16x16x32_bf16 v[104:107], v[132:135], a[4:7], v[104:107]
  ds_read_b128 v[164:167], v25 offset:2624
  s_waitcnt lgkmcnt(7)
  v_mfma_f32_16x16x32_bf16 v[104:107], v[136:139], a[8:11], v[104:107]
  ds_read_b128 v[168:171], v25 offset:2688
  s_waitcnt lgkmcnt(7)
  v_mfma_f32_16x16x32_bf16 v[104:107], v[140:143], a[12:15], v[104:107]
  ds_read_b128 v[172:175], v25 offset:2752
  s_waitcnt lgkmcnt(7)
  v_mfma_f32_16x16x32_bf16 v[104:107], v[144:147], a[16:19], v[104:107]
  ds_read_b128 v[176:179], v25 offset:3840
  s_waitcnt lgkmcnt(7)
  v_mfma_f32_16x16x32_bf16 v[104:107], v[148:151], a[20:23], v[104:107]
  ds_read_b128 v[180:183], v25 offset:3904
  s_waitcnt lgkmcnt(7)
  v_mfma_f32_16x16x32_bf16 v[104:107], v[152:155], a[24:27], v[104:107]
  ds_read_b128 v[184:187], v25 offset:3968
  s_waitcnt lgkmcnt(7)
  v_mfma_f32_16x16x32_bf16 v[104:107], v[156:159], a[28:31], v[104:107]
  ds_read_b128 v[188:191], v25 offset:4032
  s_waitcnt lgkmcnt(7)
  v_mfma_f32_16x16x32_bf16 v[104:107], v[160:163], a[32:35], v[104:107]
  s_waitcnt lgkmcnt(6)
  v_mfma_f32_16x16x32_bf16 v[104:107], v[164:167], a[36:39], v[104:107]
  s_waitcnt lgkmcnt(5)
  v_mfma_f32_16x16x32_bf16 v[104:107], v[168:171], a[40:43], v[104:107]
  s_waitcnt lgkmcnt(4)
  v_mfma_f32_16x16x32_bf16 v[104:107], v[172:175], a[44:47], v[104:107]
  s_waitcnt lgkmcnt(3)
  v_mfma_f32_16x16x32_bf16 v[104:107], v[176:179], a[48:51], v[104:107]
  s_waitcnt lgkmcnt(2)
  v_mfma_f32_16x16x32_bf16 v[104:107], v[180:183], a[52:55], v[104:107]
  s_waitcnt lgkmcnt(1)
  v_mfma_f32_16x16x32_bf16 v[104:107], v[184:187], a[56:59], v[104:107]
  s_waitcnt lgkmcnt(0)
  v_mfma_f32_16x16x32_bf16 v[104:107], v[188:191], a[60:63], v[104:107]
  s_nop 7
  v_pk_add_f32 v[104:105], v[104:105], v[106:107]
  v_add_f32 v104, v104, v105
  v_cvt_pk_bf16_f32 v104, v104, v104
  v_min_u32 v104, -2, v104
  buffer_store_short v104, v28, s[44:47], 0 offen sc1
  buffer_store_short v104, v29, s[44:47], s5 offen
  s_branch L_END
.p2align 12
L_A3:
  s_barrier
  ds_read_b64_tr_b16 a[0:1], v56 offset:0
  ds_read_b64_tr_b16 a[2:3], v56 offset:1024
  ds_read_b64_tr_b16 a[4:5], v57 offset:0
  ds_read_b64_tr_b16 a[6:7], v57 offset:1024
  ds_read_b64_tr_b16 a[8:9], v56 offset:8192
  ds_read_b64_tr_b16 a[10:11], v56 offset:9216
  ds_read_b64_tr_b16 a[12:13], v57 offset:8192
  ds_read_b64_tr_b16 a[14:15], v57 offset:9216
  ds_read_b64_tr_b16 a[16:17], v56 offset:16384
  ds_read_b64_tr_b16 a[18:19], v56 offset:17408
  ds_read_b64_tr_b16 a[20:21], v57 offset:16384
  ds_read_b64_tr_b16 a[22:23], v57 offset:17408
  ds_read_b64_tr_b16 a[24:25], v56 offset:24576
  ds_read_b64_tr_b16 a[26:27], v56 offset:25600
  ds_read_b64_tr_b16 a[28:29], v57 offset:24576
  ds_read_b64_tr_b16 a[30:31], v57 offset:25600
  buffer_load_dwordx4 v[236:239], v20, s[44:47], s68 offen sc1
  v_lshlrev_b32 v192, 16, v16
  v_and_b32 v193, 0xffff0000, v16
  v_lshlrev_b32 v194, 16, v17
  v_and_b32 v195, 0xffff0000, v17
  v_lshlrev_b32 v196, 16, v18
  v_and_b32 v197, 0xffff0000, v18
  v_lshlrev_b32 v198, 16, v19
  v_and_b32 v199, 0xffff0000, v19
  s_cmp_ge_u32 s61, 27
  s_cbranch_scc1 L_A_NOF2
  ds_read_b64_tr_b16 a[32:33], v52 offset:0
  ds_read_b64_tr_b16 a[34:35], v52 offset:512
  ds_read_b64_tr_b16 a[36:37], v52 offset:1024
  ds_read_b64_tr_b16 a[38:39], v52 offset:1536
  ds_read_b64_tr_b16 a[40:41], v52 offset:2048
  ds_read_b64_tr_b16 a[42:43], v52 offset:2560
  ds_read_b64_tr_b16 a[44:45], v52 offset:3072
  ds_read_b64_tr_b16 a[46:47], v52 offset:3584
  ds_read_b64_tr_b16 a[48:49], v42 offset:4096
  ds_read_b64_tr_b16 a[50:51], v42 offset:4608
  ds_read_b64_tr_b16 a[52:53], v42 offset:5120
  ds_read_b64_tr_b16 a[54:55], v42 offset:5632
  v_lshlrev_b32 v200, 16, v58
  v_and_b32 v201, 0xffff0000, v58
  v_lshlrev_b32 v202, 16, v59
  v_and_b32 v203, 0xffff0000, v59
  s_cmp_lt_u32 s36, 2
  s_cselect_b32 s63, 0x3f803f80, 0
  v_mov_b32 v208, 0x3f803f80
  v_mov_b32 v212, s63
  v_mov_b32 v209, 0x3f803f80
  v_mov_b32 v213, s63
  v_mov_b32 v210, 0x3f803f80
  v_mov_b32 v214, s63
  v_mov_b32 v211, 0x3f803f80
  v_mov_b32 v215, s63
  s_waitcnt lgkmcnt(0)
  v_mfma_f32_16x16x32_bf16 v[204:207], a[32:35], v[208:211], 0
  v_mfma_f32_16x16x32_bf16 v[204:207], a[36:39], v[208:211], v[204:207]
  v_mfma_f32_16x16x32_bf16 v[204:207], a[40:43], v[208:211], v[204:207]
  v_mfma_f32_16x16x32_bf16 v[204:207], a[44:47], v[208:211], v[204:207]
  v_mfma_f32_16x16x32_bf16 v[204:207], a[48:51], v[212:215], v[204:207]
  v_mfma_f32_16x16x32_bf16 v[204:207], a[52:55], v[212:215], v[204:207]
  s_nop 7
  ds_write_b128 v45, v[204:207]
  s_waitcnt lgkmcnt(0)
  s_barrier
  ds_read_b128 v[208:211], v55 offset:0
  ds_read_b128 v[212:215], v55 offset:64
  ds_read_b128 v[216:219], v55 offset:128
  ds_read_b128 v[220:223], v55 offset:192
  s_waitcnt lgkmcnt(0)
  v_pk_add_f32 v[208:209], v[208:209], v[212:213]
  v_pk_add_f32 v[216:217], v[216:217], v[220:221]
  v_pk_add_f32 v[210:211], v[210:211], v[214:215]
  v_pk_add_f32 v[218:219], v[218:219], v[222:223]
  v_pk_add_f32 v[204:205], v[208:209], v[216:217]
  v_pk_add_f32 v[206:207], v[210:211], v[218:219]
L_A_NOF2:
  s_waitcnt lgkmcnt(0)
  buffer_load_dwordx4 v[240:243], v20, s[44:47], s68 offen sc1
L_A_REC:
  s_waitcnt vmcnt(1)
  v_cmp_ne_u64 vcc, s[40:41], v[238:239]
  v_mov_b32 v64, v236
  v_mov_b32 v65, v237
  s_and_b64 vcc, vcc, s[70:71]
  s_cbranch_vccz L_A_REC_OK
  buffer_load_dwordx4 v[236:239], v20, s[44:47], s68 offen sc1
  s_waitcnt vmcnt(1)
  v_cmp_ne_u64 vcc, s[40:41], v[242:243]
  v_mov_b32 v64, v240
  v_mov_b32 v65, v241
  s_and_b64 vcc, vcc, s[70:71]
  s_cbranch_vccz L_A_REC_OK
  s_sub_u32 s42, s42, 1
  s_cmp_eq_u32 s42, 0
  s_cbranch_scc1 L_END
  s_add_u32 s4, s4, 1
  s_cmp_ge_u32 s4, 96
  s_cselect_b32 s3, 4293918719, s3
  v_and_b32 v20, s3, v20
  buffer_load_dwordx4 v[240:243], v20, s[44:47], s68 offen sc1
  s_branch L_A_REC
L_A_REC_OK:
  s_mov_b32 s6, s69
  buffer_load_dwordx4 v[128:131], v22, s[44:47], s6 offen sc1
  s_add_u32 s6, s6, 32768
  buffer_load_dwordx4 v[132:135], v22, s[44:47], s6 offen sc1
  s_add_u32 s6, s6, 32768
  buffer_load_dwordx4 v[136:139], v22, s[44:47], s6 offen sc1
  s_add_u32 s6, s6, 32768
  buffer_load_dwordx4 v[140:143], v22, s[44:47], s6 offen sc1
  s_add_u32 s6, s6, 32768
  buffer_load_dwordx4 v[144:147], v22, s[44:47], s6 offen sc1
  s_add_u32 s6, s6, 32768
  buffer_load_dwordx4 v[148:151], v22, s[44:47], s6 offen sc1
  s_add_u32 s6, s6, 32768
  buffer_load_dwordx4 v[152:155], v22, s[44:47], s6 offen sc1
  s_add_u32 s6, s6, 32768
  buffer_load_dwordx4 v[156:159], v22, s[44:47], s6 offen sc1
  buffer_load_dword v67, v26, s[44:47], s67 offen sc1
  v_mov_b32 v72, v64
  s_nop 1
  v_max_f32_dpp v72, v72, v72 quad_perm:[1,0,3,2] row_mask:0xf bank_mask:0xf
  s_nop 1
  v_max_f32_dpp v72, v72, v72 quad_perm:[2,3,0,1] row_mask:0xf bank_mask:0xf
  s_nop 1
  v_max_f32_dpp v72, v72, v72 row_half_mirror row_mask:0xf bank_mask:0xf
  v_mov_b32 v74, v72
  s_nop 1
  v_permlane16_swap_b32 v72, v74
  v_max_f32 v72, v72, v74
  v_mov_b32 v74, v72
  s_nop 1
  v_permlane32_swap_b32 v72, v74
  v_max_f32 v72, v72, v74
  v_sub_f32 v64, v64, v72
  v_exp_f32 v64, v64
  s_nop 0
  v_cvt_pk_bf16_f32 v64, v64, v64
  v_and_b32 v73, 0xffff0000, v64
  v_mul_f32 v73, v73, v65
  v_and_b32_dpp v160, v64, v36 row_newbcast:0 row_mask:0xf bank_mask:0xf
  v_and_b32_dpp v161, v64, v37 row_newbcast:0 row_mask:0xf bank_mask:0xf
  v_and_b32_dpp v162, v64, v38 row_newbcast:0 row_mask:0xf bank_mask:0xf
  v_and_b32_dpp v163, v64, v39 row_newbcast:0 row_mask:0xf bank_mask:0xf
  v_and_b32_dpp v164, v64, v36 row_newbcast:1 row_mask:0xf bank_mask:0xf
  v_and_b32_dpp v165, v64, v37 row_newbcast:1 row_mask:0xf bank_mask:0xf
  v_and_b32_dpp v166, v64, v38 row_newbcast:1 row_mask:0xf bank_mask:0xf
  v_and_b32_dpp v167, v64, v39 row_newbcast:1 row_mask:0xf bank_mask:0xf
  v_and_b32_dpp v168, v64, v36 row_newbcast:2 row_mask:0xf bank_mask:0xf
  v_and_b32_dpp v169, v64, v37 row_newbcast:2 row_mask:0xf bank_mask:0xf
  v_and_b32_dpp v170, v64, v38 row_newbcast:2 row_mask:0xf bank_mask:0xf
  v_and_b32_dpp v171, v64, v39 row_newbcast:2 row_mask:0xf bank_mask:0xf
  v_and_b32_dpp v172, v64, v36 row_newbcast:3 row_mask:0xf bank_mask:0xf
  v_and_b32_dpp v173, v64, v37 row_newbcast:3 row_mask:0xf bank_mask:0xf
  v_and_b32_dpp v174, v64, v38 row_newbcast:3 row_mask:0xf bank_mask:0xf
  v_and_b32_dpp v175, v64, v39 row_newbcast:3 row_mask:0xf bank_mask:0xf
  v_and_b32_dpp v176, v64, v36 row_newbcast:4 row_mask:0xf bank_mask:0xf
  v_and_b32_dpp v177, v64, v37 row_newbcast:4 row_mask:0xf bank_mask:0xf
  v_and_b32_dpp v178, v64, v38 row_newbcast:4 row_mask:0xf bank_mask:0xf
  v_and_b32_dpp v179, v64, v39 row_newbcast:4 row_mask:0xf bank_mask:0xf
  v_and_b32_dpp v180, v64, v36 row_newbcast:5 row_mask:0xf bank_mask:0xf
  v_and_b32_dpp v181, v64, v37 row_newbcast:5 row_mask:0xf bank_mask:0xf
  v_and_b32_dpp v182, v64, v38 row_newbcast:5 row_mask:0xf bank_mask:0xf
  v_and_b32_dpp v183, v64, v39 row_newbcast:5 row_mask:0xf bank_mask:0xf
  v_and_b32_dpp v184, v64, v36 row_newbcast:6 row_mask:0xf bank_mask:0xf
  v_and_b32_dpp v185, v64, v37 row_newbcast:6 row_mask:0xf bank_mask:0xf
  v_and_b32_dpp v186, v64, v38 row_newbcast:6 row_mask:0xf bank_mask:0xf
  v_and_b32_dpp v187, v64, v39 row_newbcast:6 row_mask:0xf bank_mask:0xf
  v_and_b32_dpp v188, v64, v36 row_newbcast:7 row_mask:0xf bank_mask:0xf
  v_and_b32_dpp v189, v64, v37 row_newbcast:7 row_mask:0xf bank_mask:0xf
  v_and_b32_dpp v190, v64, v38 row_newbcast:7 row_mask:0xf bank_mask:0xf
  v_and_b32_dpp v191, v64, v39 row_newbcast:7 row_mask:0xf bank_mask:0xf
  v_add_f32_dpp v73, v73, v73 quad_perm:[1,0,3,2] row_mask:0xf bank_mask:0xf
  s_nop 1
  v_add_f32_dpp v73, v73, v73 quad_perm:[2,3,0,1] row_mask:0xf bank_mask:0xf
  s_nop 1
  v_add_f32_dpp v73, v73, v73 row_half_mirror row_mask:0xf bank_mask:0xf
  v_mov_b32 v74, v73
  s_nop 1
  v_permlane16_swap_b32 v73, v74
  v_add_f32 v73, v73, v74
  v_mov_b32 v74, v73
  s_nop 1
  v_permlane32_swap_b32 v73, v74
  v_add_f32 v73, v73, v74
  ds_write2_b32 v21, v72, v73 offset0:0 offset1:4
L_A_DATA:
  v_sub_u32 v66, 0, v25
  s_waitcnt vmcnt(8)
  v_mfma_f32_16x16x32_bf16 v[76:79], v[160:163], v[128:131], 0
  v_add3_u32 v66, v66, v128, v129
  v_add3_u32 v66, v66, v130, v131
  s_waitcnt vmcnt(7)
  v_mfma_f32_16x16x32_bf16 v[76:79], v[164:167], v[132:135], v[76:79]
  v_add3_u32 v66, v66, v132, v133
  v_add3_u32 v66, v66, v134, v135
  s_waitcnt vmcnt(6)
  v_mfma_f32_16x16x32_bf16 v[76:79], v[168:171], v[136:139], v[76:79]
  v_add3_u32 v66, v66, v136, v137
  v_add3_u32 v66, v66, v138, v139
  s_waitcnt vmcnt(5)
  v_mfma_f32_16x16x32_bf16 v[76:79], v[172:175], v[140:143], v[76:79]
  v_add3_u32 v66, v66, v140, v141
  v_add3_u32 v66, v66, v142, v143
  s_waitcnt vmcnt(4)
  v_mfma_f32_16x16x32_bf16 v[76:79], v[176:179], v[144:147], v[76:79]
  v_add3_u32 v66, v66, v144, v145
  v_add3_u32 v66, v66, v146, v147
  s_waitcnt vmcnt(3)
  v_mfma_f32_16x16x32_bf16 v[76:79], v[180:183], v[148:151], v[76:79]
  v_add3_u32 v66, v66, v148, v149
  v_add3_u32 v66, v66, v150, v151
  s_waitcnt vmcnt(2)
  v_mfma_f32_16x16x32_bf16 v[76:79], v[184:187], v[152:155], v[76:79]
  v_add3_u32 v66, v66, v152, v153
  v_add3_u32 v66, v66, v154, v155
  s_waitcnt vmcnt(1)
  v_mfma_f32_16x16x32_bf16 v[76:79], v[188:191], v[156:159], v[76:79]
  v_add3_u32 v66, v66, v156, v157
  v_add3_u32 v66, v66, v158, v159
  s_waitcnt vmcnt(0)
  v_add_u32 v66, v66, v67
  s_nop 1
  v_add_u32_dpp v66, v66, v66 quad_perm:[1,0,3,2] row_mask:0xf bank_mask:0xf
  s_nop 0
  v_cvt_pk_bf16_f32 v74, v76, v77
  v_cvt_pk_bf16_f32 v75, v78, v79
  v_add_u32_dpp v66, v66, v66 quad_perm:[2,3,0,1] row_mask:0xf bank_mask:0xf
  ds_write_b64 v23, v[74:75]
  s_nop 0
  v_add_u32_dpp v66, v66, v66 row_half_mirror row_mask:0xf bank_mask:0xf
  s_nop 1
  v_add_u32_dpp v66, v66, v66 row_mirror row_mask:0xf bank_mask:0xf
  v_cmp_ne_u32 vcc, 0, v66
  s_cbranch_vccz L_A_DOK
  s_sub_u32 s42, s42, 1
  s_cmp_eq_u32 s42, 0
  s_cbranch_scc1 L_END
  s_mov_b64 exec, vcc
  s_mov_b32 s6, s69
  buffer_load_dwordx4 v[128:131], v22, s[44:47], s6 offen sc1
  s_add_u32 s6, s6, 32768
  buffer_load_dwordx4 v[132:135], v22, s[44:47], s6 offen sc1
  s_add_u32 s6, s6, 32768
  buffer_load_dwordx4 v[136:139], v22, s[44:47], s6 offen sc1
  s_add_u32 s6, s6, 32768
  buffer_load_dwordx4 v[140:143], v22, s[44:47], s6 offen sc1
  s_add_u32 s6, s6, 32768
  buffer_load_dwordx4 v[144:147], v22, s[44:47], s6 offen sc1
  s_add_u32 s6, s6, 32768
  buffer_load_dwordx4 v[148:151], v22, s[44:47], s6 offen sc1
  s_add_u32 s6, s6, 32768
  buffer_load_dwordx4 v[152:155], v22, s[44:47], s6 offen sc1
  s_add_u32 s6, s6, 32768
  buffer_load_dwordx4 v[156:159], v22, s[44:47], s6 offen sc1
  buffer_load_dword v67, v26, s[44:47], s67 offen sc1
  s_mov_b64 exec, -1
  s_branch L_A_DATA
L_A_DOK:
  s_waitcnt lgkmcnt(0)
  s_barrier
  ds_read_b128 v[80:83], v24
  ds_read_b128 v[64:67], v27
  ds_read_b128 v[84:87], v24 offset:64
  ds_read_b128 v[68:71], v27 offset:16
  ds_read_b128 v[88:91], v24 offset:128
  ds_read_b128 v[92:95], v24 offset:192
  s_waitcnt lgkmcnt(5)
  v_mfma_f32_16x16x32_bf16 v[104:107], v[80:83], a[0:3], 0
  v_mfma_f32_16x16x32_bf16 v[108:111], v[80:83], a[4:7], 0
  s_waitcnt lgkmcnt(4)
  v_max3_f32 v72, v64, v65, v66
  v_max_f32 v72, v72, v67
  s_waitcnt lgkmcnt(3)
  v_mfma_f32_16x16x32_bf16 v[104:107], v[84:87], a[8:11], v[104:107]
  v_sub_f32 v64, v64, v72
  v_sub_f32 v65, v65, v72
  v_mfma_f32_16x16x32_bf16 v[108:111], v[84:87], a[12:15], v[108:111]
  v_sub_f32 v66, v66, v72
  v_sub_f32 v67, v67, v72
  s_waitcnt lgkmcnt(1)
  v_mfma_f32_16x16x32_bf16 v[104:107], v[88:91], a[16:19], v[104:107]
  v_exp_f32 v64, v64
  v_mfma_f32_16x16x32_bf16 v[108:111], v[88:91], a[20:23], v[108:111]
  v_exp_f32 v65, v65
  s_waitcnt lgkmcnt(0)
  v_mfma_f32_16x16x32_bf16 v[104:107], v[92:95], a[24:27], v[104:107]
  v_exp_f32 v66, v66
  v_mfma_f32_16x16x32_bf16 v[108:111], v[92:95], a[28:31], v[108:111]
  v_exp_f32 v67, v67
  v_mul_f32 v72, v64, v68
  v_fmac_f32 v72, v65, v69
  v_fmac_f32 v72, v66, v70
  v_fmac_f32 v72, v67, v71
  v_rcp_f32 v72, v72
  v_pk_mul_f32 v[104:105], v[104:105], v[64:65]
  s_nop 0
  v_pk_mul_f32 v[108:109], v[108:109], v[64:65]
  v_pk_fma_f32 v[104:105], v[106:107], v[66:67], v[104:105]
  v_pk_fma_f32 v[108:109], v[110:111], v[66:67], v[108:109]
  v_add_f32 v104, v104, v105
  v_add_f32 v108, v108, v109
  v_mul_f32 v104, v104, v72
  v_mul_f32 v108, v108, v72
  v_cvt_pk_bf16_f32 v98, v104, v108
  buffer_store_dwordx2 v[98:99], v102, s[44:47], s5 offen
  buffer_store_dwordx2 v[98:99], v102, s[44:47], 0 offen sc1
  s_cmp_ge_u32 s61, 27
  s_cbranch_scc1 L_FIN
  s_lshl_b32 s64, s36, 10
  s_add_u32 m0, s64, 90112
  s_add_u32 s63, s64, 0
  buffer_load_dwordx4 v224, s[52:55], s63 offen nt lds
  s_add_u32 m0, s64, 94208
  s_add_u32 s63, s64, 4096
  buffer_load_dwordx4 v225, s[52:55], s63 offen nt lds
  s_add_u32 m0, s64, 98304
  s_add_u32 s63, s64, 8192
  buffer_load_dwordx4 v226, s[52:55], s63 offen nt lds
  s_add_u32 m0, s64, 102400
  s_add_u32 s63, s64, 12288
  buffer_load_dwordx4 v227, s[52:55], s63 offen nt lds
  s_add_u32 m0, s64, 106496
  s_add_u32 s63, s64, 16384
  buffer_load_dwordx4 v228, s[52:55], s63 offen nt lds
  s_mov_b32 s68, 65537
  s_mov_b32 s69, 65537
  s_mov_b32 s70, 131074
  s_mov_b32 s71, 131074
  s_mov_b32 s72, 262148
  s_mov_b32 s73, 262148
  s_mov_b32 s74, 524296
  s_mov_b32 s75, 524296
  s_mov_b32 s76, 1048592
  s_mov_b32 s77, 1048592
  v_and_b32 v46, s3, v46
  v_and_b32 v47, s3, v47
  s_waitcnt vmcnt(0)
  buffer_load_dwordx4 v[152:155], v46, s[44:47], s79 offen sc1
  buffer_load_dwordx4 v[156:159], v46, s[44:47], s79 offen offset:128 sc1
  buffer_load_dwordx4 v[160:163], v47, s[44:47], s79 offen offset:256 sc1
  s_barrier
  ds_read_b64_tr_b16 a[56:57], v229 offset:0
  ds_read_b64_tr_b16 a[58:59], v229 offset:8
  ds_read_b64_tr_b16 a[60:61], v230 offset:0
  ds_read_b64_tr_b16 a[62:63], v230 offset:8
  ds_read_b64_tr_b16 a[64:65], v231 offset:0
  ds_read_b64_tr_b16 a[66:67], v231 offset:8
  ds_read_b64_tr_b16 a[68:69], v232 offset:0
  ds_read_b64_tr_b16 a[70:71], v232 offset:8
  ds_read_b64_tr_b16 a[72:73], v233 offset:0
  ds_read_b64_tr_b16 a[74:75], v233 offset:8
  s_waitcnt lgkmcnt(0)
  buffer_load_dwordx4 v[164:167], v46, s[44:47], s79 offen sc1
  buffer_load_dwordx4 v[168:171], v46, s[44:47], s79 offen offset:128 sc1
  buffer_load_dwordx4 v[172:175], v47, s[44:47], s79 offen offset:256 sc1
L_F_POLL:
  s_waitcnt vmcnt(3)
  v_mfma_f32_16x16x32_bf16 v[76:79], v[28:31], v[152:155], v[192:195]
  v_mfma_f32_16x16x32_bf16 v[76:79], v[32:35], v[156:159], v[76:79]
  v_mfma_f32_16x16x32_bf16 v[80:83], v[28:31], v[160:163], v[196:199]
  v_max3_u32 v12, v152, v153, v154
  v_max3_u32 v12, v12, v155, v156
  v_max3_u32 v12, v12, v157, v158
  v_max3_u32 v12, v12, v159, v160
  v_max3_u32 v12, v12, v161, v162
  v_max_u32 v12, v12, v163
  v_cmp_eq_u32 vcc, -1, v12
  s_cbranch_vccz L_F_POLL_OK
  buffer_load_dwordx4 v[152:155], v46, s[44:47], s79 offen sc1
  buffer_load_dwordx4 v[156:159], v46, s[44:47], s79 offen offset:128 sc1
  buffer_load_dwordx4 v[160:163], v47, s[44:47], s79 offen offset:256 sc1
  s_waitcnt vmcnt(3)
  v_mfma_f32_16x16x32_bf16 v[76:79], v[28:31], v[164:167], v[192:195]
  v_mfma_f32_16x16x32_bf16 v[76:79], v[32:35], v[168:171], v[76:79]
  v_mfma_f32_16x16x32_bf16 v[80:83], v[28:31], v[172:175], v[196:199]
  v_max3_u32 v12, v164, v165, v166
  v_max3_u32 v12, v12, v167, v168
  v_max3_u32 v12, v12, v169, v170
  v_max3_u32 v12, v12, v171, v172
  v_max3_u32 v12, v12, v173, v174
  v_max_u32 v12, v12, v175
  v_cmp_eq_u32 vcc, -1, v12
  s_cbranch_vccz L_F_POLL_OK
  s_sub_u32 s42, s42, 1
  s_cmp_eq_u32 s42, 0
  s_cbranch_scc1 L_END
  s_add_u32 s4, s4, 1
  s_cmp_ge_u32 s4, 96
  s_cselect_b32 s3, 4293918719, s3
  v_and_b32 v46, s3, v46
  v_and_b32 v47, s3, v47
  buffer_load_dwordx4 v[164:167], v46, s[44:47], s79 offen sc1
  buffer_load_dwordx4 v[168:171], v46, s[44:47], s79 offen offset:128 sc1
  buffer_load_dwordx4 v[172:175], v47, s[44:47], s79 offen offset:256 sc1
  s_branch L_F_POLL
L_F_POLL_OK:
  v_add_f32_dpp v76, v76, v76 row_ror:8 row_mask:0xf bank_mask:0xf
  v_add_f32_dpp v77, v77, v77 row_ror:8 row_mask:0xf bank_mask:0xf
  v_add_f32_dpp v78, v78, v78 row_ror:8 row_mask:0xf bank_mask:0xf
  v_add_f32_dpp v79, v79, v79 row_ror:8 row_mask:0xf bank_mask:0xf
  v_cvt_pk_bf16_f32 v84, v76, v77
  v_cvt_pk_bf16_f32 v85, v78, v79
  ds_write_b64 v48, v[84:85]
  ds_read_b128 v[128:131], v50 offset:0
  ds_read_b128 v[132:135], v50 offset:64
  ds_read_b128 v[136:139], v50 offset:128
  ds_read_b128 v[140:143], v50 offset:192
  v_add_f32_dpp v80, v80, v80 row_ror:8 row_mask:0xf bank_mask:0xf
  v_add_f32_dpp v81, v81, v81 row_ror:8 row_mask:0xf bank_mask:0xf
  v_add_f32_dpp v82, v82, v82 row_ror:8 row_mask:0xf bank_mask:0xf
  v_add_f32_dpp v83, v83, v83 row_ror:8 row_mask:0xf bank_mask:0xf
  v_cvt_pk_bf16_f32 v86, v80, v81
  v_cvt_pk_bf16_f32 v87, v82, v83
  ds_write_b64 v49, v[86:87]
  ds_read_b128 v[144:147], v50 offset:256
  ds_read_b128 v[148:151], v50 offset:320
  v_pk_add_f32 v[88:89], v[76:77], v[78:79]
  v_pk_mul_f32 v[92:93], v[76:77], v[76:77]
  v_pk_add_f32 v[90:91], v[80:81], v[82:83]
  v_pk_fma_f32 v[92:93], v[78:79], v[78:79], v[92:93]
  v_pk_add_f32 v[88:89], v[88:89], v[90:91]
  v_pk_fma_f32 v[92:93], v[80:81], v[80:81], v[92:93]
  v_pk_fma_f32 v[92:93], v[82:83], v[82:83], v[92:93]
  s_waitcnt lgkmcnt(6)
  v_mfma_f32_16x16x32_bf16 v[96:99], a[32:35], v[128:131], 0
  v_add_f32 v88, v88, v89
  v_add_f32 v92, v92, v93
  s_waitcnt lgkmcnt(5)
  v_mfma_f32_16x16x32_bf16 v[96:99], a[36:39], v[132:135], v[96:99]
  s_nop 0
  v_permlane32_swap_b32 v88, v92
  v_add_f32 v88, v88, v92
  s_waitcnt lgkmcnt(4)
  v_mfma_f32_16x16x32_bf16 v[96:99], a[40:43], v[136:139], v[96:99]
  v_mov_b32 v92, v88
  s_waitcnt lgkmcnt(3)
  v_mfma_f32_16x16x32_bf16 v[96:99], a[44:47], v[140:143], v[96:99]
  s_nop 0
  v_permlane16_swap_b32 v88, v92
  v_add_f32 v88, v88, v92
  s_waitcnt lgkmcnt(1)
  v_mfma_f32_16x16x32_bf16 v[96:99], a[48:51], v[144:147], v[96:99]
  s_nop 0
  v_add_f32_dpp v88, v88, v88 quad_perm:[1,0,3,2] row_mask:0xf bank_mask:0xf
  s_waitcnt lgkmcnt(0)
  v_mfma_f32_16x16x32_bf16 v[96:99], a[52:55], v[148:151], v[96:99]
  v_add_f32_dpp v88, v88, v88 quad_perm:[2,3,0,1] row_mask:0xf bank_mask:0xf
  s_nop 1
  v_add_f32_dpp v88, v88, v88 row_half_mirror row_mask:0xf bank_mask:0xf
  v_mul_f32 v88, 0x3acccccd, v88
  ds_write_b32 v54, v88
  s_nop 1
  ds_write_b128 v45, v[96:99]
  s_waitcnt lgkmcnt(0)
  s_barrier
  ds_read_b128 v[100:103], v44
  ds_read_b128 v[104:107], v44 offset:16
  ds_read_b128 v[128:131], v55 offset:0
  ds_read_b128 v[132:135], v55 offset:64
  ds_read_b128 v[136:139], v55 offset:128
  ds_read_b128 v[140:143], v55 offset:192
  s_waitcnt lgkmcnt(4)
  v_pk_add_f32 v[100:101], v[100:101], v[102:103]
  v_pk_add_f32 v[104:105], v[104:105], v[106:107]
  v_add_f32 v100, v100, v101
  v_add_f32 v104, v104, v105
  v_fma_f32 v104, -v100, v100, v104
  v_max_f32 v104, 0, v104
  v_add_f32 v104, 0x3727c5ac, v104
  v_rsq_f32 v104, v104
  s_waitcnt lgkmcnt(0)
  v_pk_fma_f32 v[128:129], v[204:205], v[100:101], v[128:129] op_sel_hi:[1,0,1] neg_lo:[0,1,0] neg_hi:[0,1,0]
  v_pk_fma_f32 v[130:131], v[206:207], v[100:101], v[130:131] op_sel_hi:[1,0,1] neg_lo:[0,1,0] neg_hi:[0,1,0]
  v_pk_add_f32 v[136:137], v[136:137], v[140:141]
  v_pk_add_f32 v[138:139], v[138:139], v[142:143]
  v_pk_add_f32 v[128:129], v[128:129], v[132:133]
  v_pk_add_f32 v[130:131], v[130:131], v[134:135]
  v_pk_add_f32 v[128:129], v[128:129], v[136:137]
  v_pk_add_f32 v[130:131], v[130:131], v[138:139]
  v_pk_fma_f32 v[128:129], v[128:129], v[104:105], v[200:201] op_sel_hi:[1,0,1]
  v_pk_fma_f32 v[130:131], v[130:131], v[104:105], v[202:203] op_sel_hi:[1,0,1]
  v_max_f32 v128, 0, v128
  v_max_f32 v129, 0, v129
  v_max_f32 v130, 0, v130
  v_max_f32 v131, 0, v131
  v_pk_mul_f32 v[128:129], v[128:129], v[128:129]
  v_pk_mul_f32 v[130:131], v[130:131], v[130:131]
  v_cvt_pk_bf16_f32 v108, v128, v129
  v_cvt_pk_bf16_f32 v109, v130, v131
  v_cndmask_b32 v110, 0, v108, s[68:69]
  v_cndmask_b32 v111, 0, v109, s[68:69]
  v_cndmask_b32 v112, 0, v108, s[70:71]
  v_cndmask_b32 v113, 0, v109, s[70:71]
  v_mfma_f32_16x16x16_bf16 v[120:123], a[56:57], v[110:111], 0
  v_cndmask_b32 v114, 0, v108, s[72:73]
  v_cndmask_b32 v115, 0, v109, s[72:73]
  v_mfma_f32_16x16x16_bf16 v[124:127], a[58:59], v[110:111], 0
  v_mfma_f32_16x16x16_bf16 v[120:123], a[60:61], v[112:113], v[120:123]
  v_cndmask_b32 v116, 0, v108, s[74:75]
  v_cndmask_b32 v117, 0, v109, s[74:75]
  v_mfma_f32_16x16x16_bf16 v[124:127], a[62:63], v[112:113], v[124:127]
  v_mfma_f32_16x16x16_bf16 v[120:123], a[64:65], v[114:115], v[120:123]
  v_cndmask_b32 v118, 0, v108, s[76:77]
  v_cndmask_b32 v119, 0, v109, s[76:77]
  v_mfma_f32_16x16x16_bf16 v[124:127], a[66:67], v[114:115], v[124:127]
  v_mfma_f32_16x16x16_bf16 v[120:123], a[68:69], v[116:117], v[120:123]
  v_mfma_f32_16x16x16_bf16 v[124:127], a[70:71], v[116:117], v[124:127]
  v_mfma_f32_16x16x16_bf16 v[120:123], a[72:73], v[118:119], v[120:123]
  v_mfma_f32_16x16x16_bf16 v[124:127], a[74:75], v[118:119], v[124:127]
  s_nop 6
  v_cvt_pk_bf16_f32 v64, v120, v121
  v_cvt_pk_bf16_f32 v65, v122, v123
  v_cvt_pk_bf16_f32 v66, v124, v125
  v_cvt_pk_bf16_f32 v67, v126, v127
  v_min_u32 v64, -2, v64
  v_min_u32 v65, -2, v65
  v_min_u32 v66, -2, v66
  v_min_u32 v67, -2, v67
  buffer_store_dwordx4 v[64:67], v51, s[44:47], 0 offen sc1
  buffer_store_dwordx4 v[64:67], v43, s[44:47], s5 offen
  s_branch L_END
.p2align 12
L_T2:
  s_waitcnt vmcnt(10)
  ds_read_b128 a[68:71], v56 offset:4096
  ds_read_b128 a[76:79], v57 offset:4096
  ds_read_b128 a[84:87], v58 offset:4096
  ds_read_b128 a[92:95], v59 offset:4096
  ds_read_b128 a[100:103], v56 offset:36864
  ds_read_b128 a[108:111], v57 offset:36864
  ds_read_b128 a[116:119], v58 offset:36864
  ds_read_b128 a[124:127], v59 offset:36864
  s_barrier
  ds_read_b64_tr_b16 a[146:147], v34 offset:4096
  ds_read_b64_tr_b16 a[150:151], v35 offset:4096
  ds_read_b64_tr_b16 a[178:179], v34 offset:12288
  ds_read_b64_tr_b16 a[182:183], v35 offset:12288
  ds_read_b64_tr_b16 a[210:211], v34 offset:20480
  ds_read_b64_tr_b16 a[214:215], v35 offset:20480
  ds_read_b64_tr_b16 a[242:243], v34 offset:28672
  ds_read_b64_tr_b16 a[246:247], v35 offset:28672
  ds_read_b64_tr_b16 a[154:155], v34 offset:36864
  ds_read_b64_tr_b16 a[158:159], v35 offset:36864
  ds_read_b64_tr_b16 a[186:187], v34 offset:45056
  ds_read_b64_tr_b16 a[190:191], v35 offset:45056
  ds_read_b64_tr_b16 a[218:219], v34 offset:53248
  ds_read_b64_tr_b16 a[222:223], v35 offset:53248
  ds_read_b64_tr_b16 a[250:251], v34 offset:61440
  ds_read_b64_tr_b16 a[254:255], v35 offset:61440
  s_lshl_b32 s64, s61, 7
  s_add_u32 s73, s73, s64
  s_add_u32 s48, s18, s73
  s_addc_u32 s49, s19, 0
  s_and_b32 s49, s49, 0xffff
  s_sub_u32 s50, 5242880, s73
  s_mov_b32 s51, 0x20000
  s_cmp_lt_u32 s61, 10
  s_cselect_b32 s50, s50, 0
  s_branch L_T_Q1
L_T_Q1:
  s_waitcnt vmcnt(9)
  v_cmp_lt_u32 vcc, 0xffffff, v69
  v_and_b32 v69, 0xffffff, v69
  s_and_b32 s11, vcc_lo, 15
  v_cmp_eq_u32 vcc, 0, v69
  v_add_u32_dpp v69, v69, v69 quad_perm:[1,0,3,2] row_mask:0xf bank_mask:0xf
  s_nop 1
  v_add_u32_dpp v69, v69, v69 quad_perm:[2,3,0,1] row_mask:0xf bank_mask:0xf
  s_nop 1
  v_add_u32_dpp v69, v69, v69 row_half_mirror row_mask:0xf bank_mask:0xf
  s_nop 0
  v_readlane_b32 s8, v69, 0
  v_readlane_b32 s9, v69, 8
  v_readlane_b32 s10, v69, 16
  s_sub_u32 s12, s8, s9
  s_add_u32 s12, s12, s10
  s_lshl1_add_u32 s8, s8, s12
  s_lshl1_add_u32 s10, s10, s12
  s_lshl_b32 s9, s9, 1
  s_sub_u32 s9, s9, s12
  s_cmp_lt_u32 s8, 1572864
  s_cselect_b32 s8, 8192, 0
  s_cmp_lt_u32 s9, 524288
  s_cselect_b32 s9, 8192, 0
  s_cmp_lt_u32 s10, 1572864
  s_cselect_b32 s10, 8192, 0
  s_cbranch_vccnz L_T_Q0
  v_bfe_u32 v12, s11, v2, 1
  v_lshlrev_b32 v12, 13, v12
  v_xor_b32 v13, s9, v12
  v_xor_b32 v26, v13, v5
  v_xor_b32 v27, 0x2000, v26
  s_cmp_lt_u32 s37, 4
  s_cselect_b32 s9, s9, s10
  v_xor_b32 v13, s9, v12
  v_xor_b32 v24, v13, v40
  v_xor_b32 v25, 0x2000, v24
  v_xor_b32 v12, s8, v12
  v_xor_b32 v15, v12, v41
  v_xor_b32 v32, v12, v4
  s_getreg_b32 s12, hwreg(HW_REG_XCC_ID, 2, 1)
  s_lshl_b32 s12, s12, 13
  s_xor_b32 s12, s12, s8
  s_and_b32 s13, s76, s5
  s_cselect_b32 s13, 0, s12
  s_andn2_b32 s76, s76, 0x2000
  s_or_b32 s76, s76, s13
  v_mov_b32 v12, s13
  s_and_b32 s13, s77, s5
  s_cselect_b32 s13, 0, s12
  s_andn2_b32 s77, s77, 0x2000
  s_or_b32 s77, s77, s13
  v_mov_b32 v13, s13
  v_cmp_gt_u32 vcc, 32, v0
  s_nop 1
  v_cndmask_b32 v12, v13, v12, vcc
  v_and_b32 v46, 0xffffdfff, v46
  v_or_b32 v46, v46, v12
L_T_Q3:
  s_waitcnt vmcnt(0)
  ds_read_b32 v12, v6
  ds_read_b32 v13, v7 offset:1024
  v_add_u32 v14, v80, v82
  v_sub_u32 v14, 0, v14
  ds_write_b32 v10, v14
  v_xor_b32 v81, s40, v81
  v_xor_b32 v83, s40, v83
  s_waitcnt lgkmcnt(0)
  v_xor_b32 v12, v12, v81
  v_xor_b32 v13, v13, v83
  v_or_b32 v12, v12, v13
  v_cmp_ne_u32 vcc, 0, v12
  s_cbranch_vccnz L_T_Q2
  s_barrier
  ds_read_b128 v[128:131], v28 offset:0
  ds_read_b128 v[132:135], v29 offset:0
  ds_read_b128 v[136:139], v30 offset:0
  ds_read_b128 v[140:143], v31 offset:0
  v_mov_b32 v23, 0
  buffer_store_dwordx4 v[16:19], v20, s[44:47], s71 offen sc1
  s_waitcnt lgkmcnt(3)
  v_mfma_f32_16x16x32_bf16 v[48:51], a[0:3], v[128:131], 0
  ds_read_b128 v[144:147], v28 offset:256
  v_add3_u32 v23, v23, v128, v130
  v_mfma_f32_16x16x32_bf16 v[56:59], a[4:7], v[128:131], 0
  ds_read_b128 v[148:151], v29 offset:256
  s_add_u32 m0, s74, 0
  s_mov_b32 s6, 0
  buffer_load_dwordx4 v36, s[48:51], s6 offen nt lds
  s_waitcnt lgkmcnt(4)
  v_mfma_f32_16x16x32_bf16 v[48:51], a[8:11], v[132:135], v[48:51]
  ds_read_b128 v[152:155], v30 offset:256
  v_add3_u32 v23, v23, v132, v134
  v_mfma_f32_16x16x32_bf16 v[56:59], a[12:15], v[132:135], v[56:59]
  ds_read_b128 v[156:159], v31 offset:256
  s_add_u32 m0, s74, 1024
  s_mov_b32 s6, 5120
  buffer_load_dwordx4 v37, s[48:51], s6 offen nt lds
  s_waitcnt lgkmcnt(5)
  v_mfma_f32_16x16x32_bf16 v[48:51], a[16:19], v[136:139], v[48:51]
  ds_read_b128 v[160:163], v28 offset:512
  v_add3_u32 v23, v23, v136, v138
  v_mfma_f32_16x16x32_bf16 v[56:59], a[20:23], v[136:139], v[56:59]
  ds_read_b128 v[164:167], v29 offset:512
  s_add_u32 m0, s74, 2048
  s_mov_b32 s6, 10240
  buffer_load_dwordx4 v36, s[48:51], s6 offen nt lds
  s_waitcnt lgkmcnt(6)
  v_mfma_f32_16x16x32_bf16 v[48:51], a[24:27], v[140:143], v[48:51]
  ds_read_b128 v[168:171], v30 offset:512
  v_add3_u32 v23, v23, v140, v142
  v_mfma_f32_16x16x32_bf16 v[56:59], a[28:31], v[140:143], v[56:59]
  ds_read_b128 v[172:175], v31 offset:512
  s_add_u32 m0, s74, 3072
  s_mov_b32 s6, 15360
  buffer_load_dwordx4 v37, s[48:51], s6 offen nt lds
  s_waitcnt lgkmcnt(7)
  v_mfma_f32_16x16x32_bf16 v[48:51], a[32:35], v[144:147], v[48:51]
  ds_read_b128 v[176:179], v28 offset:768
  v_add3_u32 v23, v23, v144, v146
  v_mfma_f32_16x16x32_bf16 v[56:59], a[36:39], v[144:147], v[56:59]
  ds_read_b128 v[180:183], v29 offset:768
  s_add_u32 m0, s74, 4096
  s_mov_b32 s6, 40960
  buffer_load_dwordx4 v36, s[48:51], s6 offen nt lds
  s_waitcnt lgkmcnt(8)
  v_mfma_f32_16x16x32_bf16 v[48:51], a[40:43], v[148:151], v[48:51]
  ds_read_b128 v[184:187], v30 offset:768
  v_add3_u32 v23, v23, v148, v150
  v_mfma_f32_16x16x32_bf16 v[56:59], a[44:47], v[148:151], v[56:59]
  ds_read_b128 v[188:191], v31 offset:768
  s_add_u32 m0, s74, 5120
  s_mov_b32 s6, 46080
  buffer_load_dwordx4 v37, s[48:51], s6 offen nt lds
  s_waitcnt lgkmcnt(9)
  v_mfma_f32_16x16x32_bf16 v[48:51], a[48:51], v[152:155], v[48:51]
  ds_read_b128 v[192:195], v28 offset:16384
  v_add3_u32 v23, v23, v152, v154
  v_mfma_f32_16x16x32_bf16 v[56:59], a[52:55], v[152:155], v[56:59]
  ds_read_b128 v[196:199], v29 offset:16384
  s_add_u32 m0, s74, 6144
  s_mov_b32 s6, 51200
  buffer_load_dwordx4 v36, s[48:51], s6 offen nt lds
  s_waitcnt lgkmcnt(10)
  v_mfma_f32_16x16x32_bf16 v[48:51], a[56:59], v[156:159], v[48:51]
  ds_read_b128 v[200:203], v30 offset:16384
  v_add3_u32 v23, v23, v156, v158
  v_mfma_f32_16x16x32_bf16 v[56:59], a[60:63], v[156:159], v[56:59]
  ds_read_b128 v[204:207], v31 offset:16384
  s_add_u32 m0, s74, 7168
  s_mov_b32 s6, 56320
  buffer_load_dwordx4 v37, s[48:51], s6 offen nt lds
  s_waitcnt lgkmcnt(11)
  v_mfma_f32_16x16x32_bf16 v[48:51], a[64:67], v[160:163], v[48:51]
  ds_read_b128 v[208:211], v28 offset:16640
  v_add3_u32 v23, v23, v160, v162
  v_mfma_f32_16x16x32_bf16 v[56:59], a[68:71], v[160:163], v[56:59]
  ds_read_b128 v[212:215], v29 offset:16640
  s_waitcnt lgkmcnt(12)
  v_mfma_f32_16x16x32_bf16 v[48:51], a[72:75], v[164:167], v[48:51]
  ds_read_b128 v[216:219], v30 offset:16640
  v_add3_u32 v23, v23, v164, v166
  v_mfma_f32_16x16x32_bf16 v[56:59], a[76:79], v[164:167], v[56:59]
  ds_read_b128 v[220:223], v31 offset:16640
  s_waitcnt lgkmcnt(13)
  v_mfma_f32_16x16x32_bf16 v[48:51], a[80:83], v[168:171], v[48:51]
  ds_read_b128 v[224:227], v28 offset:16896
  v_add3_u32 v23, v23, v168, v170
  v_mfma_f32_16x16x32_bf16 v[56:59], a[84:87], v[168:171], v[56:59]
  ds_read_b128 v[228:231], v29 offset:16896
  s_waitcnt lgkmcnt(14)
  v_mfma_f32_16x16x32_bf16 v[48:51], a[88:91], v[172:175], v[48:51]
  ds_read_b128 v[232:235], v30 offset:16896
  v_add3_u32 v23, v23, v172, v174
  v_mfma_f32_16x16x32_bf16 v[56:59], a[92:95], v[172:175], v[56:59]
  ds_read_b128 v[236:239], v31 offset:16896
  s_waitcnt lgkmcnt(15)
  v_mfma_f32_16x16x32_bf16 v[48:51], a[96:99], v[176:179], v[48:51]
  ds_read_b128 v[240:243], v28 offset:17152
  v_add3_u32 v23, v23, v176, v178
  v_mfma_f32_16x16x32_bf16 v[56:59], a[100:103], v[176:179], v[56:59]
  ds_read_b128 v[244:247], v29 offset:17152
  s_waitcnt lgkmcnt(15)
  v_mfma_f32_16x16x32_bf16 v[48:51], a[104:107], v[180:183], v[48:51]
  ds_read_b128 v[248:251], v30 offset:17152
  v_add3_u32 v23, v23, v180, v182
  v_mfma_f32_16x16x32_bf16 v[56:59], a[108:111], v[180:183], v[56:59]
  ds_read_b128 v[252:255], v31 offset:17152
  s_waitcnt lgkmcnt(15)
  v_mfma_f32_16x16x32_bf16 v[48:51], a[112:115], v[184:187], v[48:51]
  v_add3_u32 v23, v23, v184, v186
  v_mfma_f32_16x16x32_bf16 v[56:59], a[116:119], v[184:187], v[56:59]
  ds_read_b128 v[80:83], v8
  s_waitcnt lgkmcnt(15)
  s_barrier
  v_mfma_f32_16x16x32_bf16 v[48:51], a[120:123], v[188:191], v[48:51]
  v_add3_u32 v23, v23, v188, v190
  v_mfma_f32_16x16x32_bf16 v[56:59], a[124:127], v[188:191], v[56:59]
  s_waitcnt lgkmcnt(0)
  v_mfma_f32_16x16x32_bf16 v[52:55], a[0:3], v[192:195], 0
  v_add3_u32 v23, v23, v192, v194
  v_add3_u32 v23, v23, v196, v198
  v_mfma_f32_16x16x32_bf16 v[60:63], a[4:7], v[192:195], 0
  v_add3_u32 v23, v23, v200, v202
  v_add3_u32 v23, v23, v204, v206
  v_mfma_f32_16x16x32_bf16 v[52:55], a[8:11], v[196:199], v[52:55]
  v_max3_f32 v64, v48, v49, v50
  v_max3_f32 v65, v56, v57, v58
  v_mfma_f32_16x16x32_bf16 v[60:63], a[12:15], v[196:199], v[60:63]
  v_max3_f32 v64, v64, v51, v59
  v_max_f32 v64, v64, v65
  v_mfma_f32_16x16x32_bf16 v[52:55], a[16:19], v[200:203], v[52:55]
  v_mov_b32 v65, v64
  v_add3_u32 v23, v23, v208, v210
  v_mfma_f32_16x16x32_bf16 v[60:63], a[20:23], v[200:203], v[60:63]
  v_permlane32_swap_b32 v64, v65
  v_max_f32 v64, v64, v65
  v_mfma_f32_16x16x32_bf16 v[52:55], a[24:27], v[204:207], v[52:55]
  v_mov_b32 v65, v64
  v_add3_u32 v23, v23, v212, v214
  v_mfma_f32_16x16x32_bf16 v[60:63], a[28:31], v[204:207], v[60:63]
  v_permlane16_swap_b32 v64, v65
  v_max_f32 v64, v64, v65
  v_mfma_f32_16x16x32_bf16 v[52:55], a[32:35], v[208:211], v[52:55]
  ds_write_b32 v22, v64 offset:0
  v_add3_u32 v23, v23, v216, v218
  v_mfma_f32_16x16x32_bf16 v[60:63], a[36:39], v[208:211], v[60:63]
  v_add3_u32 v23, v23, v220, v222
  v_add3_u32 v23, v23, v224, v226
  v_mfma_f32_16x16x32_bf16 v[52:55], a[40:43], v[212:215], v[52:55]
  v_add3_u32 v23, v23, v228, v230
  v_add3_u32 v23, v23, v232, v234
  v_mfma_f32_16x16x32_bf16 v[60:63], a[44:47], v[212:215], v[60:63]
  s_waitcnt lgkmcnt(0)
  s_barrier
  ds_read_b128 v[72:75], v43 offset:0
  v_add3_u32 v23, v23, v236, v238
  v_mfma_f32_16x16x32_bf16 v[52:55], a[48:51], v[216:219], v[52:55]
  v_add3_u32 v23, v23, v240, v242
  v_add3_u32 v23, v23, v244, v246
  v_mfma_f32_16x16x32_bf16 v[60:63], a[52:55], v[216:219], v[60:63]
  v_add3_u32 v23, v23, v248, v250
  v_add3_u32 v23, v23, v252, v254
  v_mfma_f32_16x16x32_bf16 v[52:55], a[56:59], v[220:223], v[52:55]
  s_waitcnt lgkmcnt(0)
  v_max3_f32 v66, v72, v73, v74
  v_max_f32 v66, v66, v75
  v_mfma_f32_16x16x32_bf16 v[60:63], a[60:63], v[220:223], v[60:63]
  v_mul_f32 v66, v38, v66
  v_fma_f32 v48, v48, v38, -v66
  v_mfma_f32_16x16x32_bf16 v[52:55], a[64:67], v[224:227], v[52:55]
  v_fma_f32 v49, v49, v38, -v66
  v_fma_f32 v50, v50, v38, -v66
  v_mfma_f32_16x16x32_bf16 v[60:63], a[68:71], v[224:227], v[60:63]
  v_fma_f32 v51, v51, v38, -v66
  v_fma_f32 v56, v56, v38, -v66
  v_mfma_f32_16x16x32_bf16 v[52:55], a[72:75], v[228:231], v[52:55]
  v_fma_f32 v57, v57, v38, -v66
  v_fma_f32 v58, v58, v38, -v66
  v_mfma_f32_16x16x32_bf16 v[60:63], a[76:79], v[228:231], v[60:63]
  v_fma_f32 v59, v59, v38, -v66
  v_add3_u32 v23, v23, v80, v81
  v_mfma_f32_16x16x32_bf16 v[52:55], a[80:83], v[232:235], v[52:55]
  v_exp_f32 v48, v48
  v_mfma_f32_16x16x32_bf16 v[60:63], a[84:87], v[232:235], v[60:63]
  v_exp_f32 v49, v49
  v_mfma_f32_16x16x32_bf16 v[52:55], a[88:91], v[236:239], v[52:55]
  v_exp_f32 v50, v50
  v_mfma_f32_16x16x32_bf16 v[60:63], a[92:95], v[236:239], v[60:63]
  v_exp_f32 v51, v51
  v_mfma_f32_16x16x32_bf16 v[52:55], a[96:99], v[240:243], v[52:55]
  v_exp_f32 v56, v56
  v_mfma_f32_16x16x32_bf16 v[60:63], a[100:103], v[240:243], v[60:63]
  v_exp_f32 v57, v57
  v_mfma_f32_16x16x32_bf16 v[52:55], a[104:107], v[244:247], v[52:55]
  v_exp_f32 v58, v58
  v_mfma_f32_16x16x32_bf16 v[60:63], a[108:111], v[244:247], v[60:63]
  v_exp_f32 v59, v59
  v_mfma_f32_16x16x32_bf16 v[52:55], a[112:115], v[248:251], v[52:55]
  v_cvt_pk_bf16_f32 v76, v48, v49
  v_cvt_pk_bf16_f32 v77, v50, v51
  v_mfma_f32_16x16x32_bf16 v[60:63], a[116:119], v[248:251], v[60:63]
  v_cvt_pk_bf16_f32 v78, v56, v57
  v_cvt_pk_bf16_f32 v79, v58, v59
  v_mfma_f32_16x16x32_bf16 v[52:55], a[120:123], v[252:255], v[52:55]
  ds_write_b128 v44, v[76:79] offset:0
  v_add3_u32 v23, v23, v82, v83
  v_mfma_f32_16x16x32_bf16 v[60:63], a[124:127], v[252:255], v[60:63]
  s_nop 0
  v_add_u32_dpp v23, v23, v23 quad_perm:[1,0,3,2] row_mask:0xf bank_mask:0xf
  s_nop 1
  v_add_u32_dpp v23, v23, v23 quad_perm:[2,3,0,1] row_mask:0xf bank_mask:0xf
  v_max3_f32 v64, v52, v53, v54
  s_nop 1
  v_max3_f32 v65, v60, v61, v62
  v_add_u32_dpp v23, v23, v23 row_half_mirror row_mask:0xf bank_mask:0xf
  v_max3_f32 v64, v64, v55, v63
  v_max_f32 v64, v64, v65
  v_add_u32_dpp v23, v23, v23 row_mirror row_mask:0xf bank_mask:0xf
  v_mov_b32 v65, v64
  v_mov_b32 v69, v23
  s_nop 0
  v_permlane32_swap_b32 v64, v65
  v_permlane16_swap_b32 v23, v69
  v_max_f32 v64, v64, v65
  v_add_u32 v23, v23, v69
  v_mov_b32 v65, v64
  v_mov_b32 v69, v23
  s_nop 0
  v_permlane16_swap_b32 v64, v65
  v_max_f32 v64, v64, v65
  ds_write_b32 v22, v64 offset:256
  v_permlane32_swap_b32 v23, v69
  v_add_u32 v23, v23, v69
  v_cmp_ne_u32 vcc, 0, v23
  s_waitcnt lgkmcnt(0)
  s_barrier
  s_cbranch_vccnz L_T_Q0
  ds_read_b128 v[88:91], v45 offset:0
  ds_read_b128 v[96:99], v45 offset:2048
  ds_read_b128 v[104:107], v45 offset:4096
  ds_read_b128 v[112:115], v45 offset:6144
  ds_read_b128 v[72:75], v43 offset:256
  v_add_f32 v48, v48, v49
  v_add_f32 v50, v50, v51
  v_add_f32 v56, v56, v57
  v_add_f32 v58, v58, v59
  v_add_f32 v48, v48, v50
  v_add_f32 v56, v56, v58
  v_add_f32 v70, v48, v56
  s_waitcnt lgkmcnt(4)
  v_mfma_f32_16x16x32_bf16 v[128:131], v[88:91], a[128:131], 0
  v_mfma_f32_16x16x32_bf16 v[132:135], v[88:91], a[132:135], 0
  s_waitcnt lgkmcnt(0)
  v_max3_f32 v67, v72, v73, v74
  v_max_f32 v67, v67, v75
  v_mfma_f32_16x16x32_bf16 v[136:139], v[88:91], a[136:139], 0
  v_mul_f32 v67, v38, v67
  v_fma_f32 v52, v52, v38, -v67
  v_mfma_f32_16x16x32_bf16 v[140:143], v[88:91], a[140:143], 0
  v_fma_f32 v53, v53, v38, -v67
  v_fma_f32 v54, v54, v38, -v67
  v_mfma_f32_16x16x32_bf16 v[144:147], v[88:91], a[144:147], 0
  v_fma_f32 v55, v55, v38, -v67
  v_fma_f32 v60, v60, v38, -v67
  v_mfma_f32_16x16x32_bf16 v[148:151], v[88:91], a[148:151], 0
  v_fma_f32 v61, v61, v38, -v67
  v_fma_f32 v62, v62, v38, -v67
  v_mfma_f32_16x16x32_bf16 v[152:155], v[88:91], a[152:155], 0
  v_fma_f32 v63, v63, v38, -v67
  v_mfma_f32_16x16x32_bf16 v[156:159], v[88:91], a[156:159], 0
  v_exp_f32 v52, v52
  v_mfma_f32_16x16x32_bf16 v[128:131], v[96:99], a[160:163], v[128:131]
  v_exp_f32 v53, v53
  v_mfma_f32_16x16x32_bf16 v[132:135], v[96:99], a[164:167], v[132:135]
  v_exp_f32 v54, v54
  v_mfma_f32_16x16x32_bf16 v[136:139], v[96:99], a[168:171], v[136:139]
  v_exp_f32 v55, v55
  v_mfma_f32_16x16x32_bf16 v[140:143], v[96:99], a[172:175], v[140:143]
  v_exp_f32 v60, v60
  v_mfma_f32_16x16x32_bf16 v[144:147], v[96:99], a[176:179], v[144:147]
  v_exp_f32 v61, v61
  v_mfma_f32_16x16x32_bf16 v[148:151], v[96:99], a[180:183], v[148:151]
  v_exp_f32 v62, v62
  v_mfma_f32_16x16x32_bf16 v[152:155], v[96:99], a[184:187], v[152:155]
  v_exp_f32 v63, v63
  v_mfma_f32_16x16x32_bf16 v[156:159], v[96:99], a[188:191], v[156:159]
  v_cvt_pk_bf16_f32 v80, v52, v53
  v_cvt_pk_bf16_f32 v81, v54, v55
  v_mfma_f32_16x16x32_bf16 v[128:131], v[104:107], a[192:195], v[128:131]
  v_cvt_pk_bf16_f32 v82, v60, v61
  v_cvt_pk_bf16_f32 v83, v62, v63
  v_mfma_f32_16x16x32_bf16 v[132:135], v[104:107], a[196:199], v[132:135]
  ds_write_b128 v44, v[80:83] offset:1024
  v_add_f32 v52, v52, v53
  v_mfma_f32_16x16x32_bf16 v[136:139], v[104:107], a[200:203], v[136:139]
  v_add_f32 v54, v54, v55
  v_add_f32 v60, v60, v61
  v_mfma_f32_16x16x32_bf16 v[140:143], v[104:107], a[204:207], v[140:143]
  v_add_f32 v62, v62, v63
  v_add_f32 v52, v52, v54
  v_mfma_f32_16x16x32_bf16 v[144:147], v[104:107], a[208:211], v[144:147]
  v_add_f32 v60, v60, v62
  v_add_f32 v71, v52, v60
  v_mfma_f32_16x16x32_bf16 v[148:151], v[104:107], a[212:215], v[148:151]
  s_nop 0
  v_permlane32_swap_b32 v70, v71
  v_add_f32 v70, v70, v71
  v_mfma_f32_16x16x32_bf16 v[152:155], v[104:107], a[216:219], v[152:155]
  v_mov_b32 v71, v70
  ds_read_b128 v[76:79], v47
  v_mfma_f32_16x16x32_bf16 v[156:159], v[104:107], a[220:223], v[156:159]
  v_permlane16_swap_b32 v70, v71
  v_add_f32 v70, v70, v71
  v_mfma_f32_16x16x32_bf16 v[128:131], v[112:115], a[224:227], v[128:131]
  ds_write_b32 v42, v70 offset:512
  v_mfma_f32_16x16x32_bf16 v[132:135], v[112:115], a[228:231], v[132:135]
  v_mfma_f32_16x16x32_bf16 v[136:139], v[112:115], a[232:235], v[136:139]
  s_waitcnt lgkmcnt(0)
  s_barrier
  ds_read_b128 v[92:95], v45 offset:1024
  ds_read_b128 v[100:103], v45 offset:3072
  v_mfma_f32_16x16x32_bf16 v[140:143], v[112:115], a[236:239], v[140:143]
  ds_read_b128 v[108:111], v45 offset:5120
  ds_read_b128 v[116:119], v45 offset:7168
  v_mfma_f32_16x16x32_bf16 v[144:147], v[112:115], a[240:243], v[144:147]
  ds_read_b128 v[72:75], v47 offset:512
  v_mfma_f32_16x16x32_bf16 v[148:151], v[112:115], a[244:247], v[148:151]
  v_mfma_f32_16x16x32_bf16 v[152:155], v[112:115], a[248:251], v[152:155]
  v_mfma_f32_16x16x32_bf16 v[156:159], v[112:115], a[252:255], v[156:159]
  s_waitcnt lgkmcnt(0)
  v_mfma_f32_16x16x32_bf16 v[160:163], v[92:95], a[128:131], 0
  v_max3_f32 v84, v76, v77, v78
  v_max_f32 v84, v84, v79
  v_mfma_f32_16x16x32_bf16 v[164:167], v[92:95], a[132:135], 0
  v_mul_f32 v84, v38, v84
  v_mov_b32 v86, s40
  v_mfma_f32_16x16x32_bf16 v[168:171], v[92:95], a[136:139], 0
  v_cvt_pk_bf16_f32 v192, v128, v132
  v_cvt_pk_bf16_f32 v193, v136, v140
  v_mfma_f32_16x16x32_bf16 v[172:175], v[92:95], a[140:143], 0
  v_cvt_pk_bf16_f32 v194, v144, v148
  v_cvt_pk_bf16_f32 v195, v152, v156
  v_mfma_f32_16x16x32_bf16 v[176:179], v[92:95], a[144:147], 0
  buffer_store_dwordx4 v[192:195], v24, s[44:47], 0 offen offset:0 sc1
  v_add3_u32 v48, v192, v193, v194
  v_mfma_f32_16x16x32_bf16 v[180:183], v[92:95], a[148:151], 0
  v_add_u32 v48, v48, v195
  v_cvt_pk_bf16_f32 v196, v129, v133
  v_mfma_f32_16x16x32_bf16 v[184:187], v[92:95], a[152:155], 0
  v_cvt_pk_bf16_f32 v197, v137, v141
  v_cvt_pk_bf16_f32 v198, v145, v149
  v_mfma_f32_16x16x32_bf16 v[188:191], v[92:95], a[156:159], 0
  v_cvt_pk_bf16_f32 v199, v153, v157
  buffer_store_dwordx4 v[196:199], v24, s[44:47], 0 offen offset:1024 sc1
  v_mfma_f32_16x16x32_bf16 v[160:163], v[100:103], a[160:163], v[160:163]
  v_add3_u32 v49, v196, v197, v198
  v_add_u32 v49, v49, v199
  v_mfma_f32_16x16x32_bf16 v[164:167], v[100:103], a[164:167], v[164:167]
  v_cvt_pk_bf16_f32 v200, v130, v134
  v_cvt_pk_bf16_f32 v201, v138, v142
  v_mfma_f32_16x16x32_bf16 v[168:171], v[100:103], a[168:171], v[168:171]
  v_cvt_pk_bf16_f32 v202, v146, v150
  v_cvt_pk_bf16_f32 v203, v154, v158
  v_mfma_f32_16x16x32_bf16 v[172:175], v[100:103], a[172:175], v[172:175]
  buffer_store_dwordx4 v[200:203], v24, s[44:47], 0 offen offset:2048 sc1
  v_add3_u32 v50, v200, v201, v202
  v_mfma_f32_16x16x32_bf16 v[176:179], v[100:103], a[176:179], v[176:179]
  v_add_u32 v50, v50, v203
  v_cvt_pk_bf16_f32 v204, v131, v135
  v_mfma_f32_16x16x32_bf16 v[180:183], v[100:103], a[180:183], v[180:183]
  v_cvt_pk_bf16_f32 v205, v139, v143
  v_cvt_pk_bf16_f32 v206, v147, v151
  v_mfma_f32_16x16x32_bf16 v[184:187], v[100:103], a[184:187], v[184:187]
  v_cvt_pk_bf16_f32 v207, v155, v159
  buffer_store_dwordx4 v[204:207], v24, s[44:47], 0 offen offset:3072 sc1
  v_mfma_f32_16x16x32_bf16 v[188:191], v[100:103], a[188:191], v[188:191]
  v_add3_u32 v51, v204, v205, v206
  v_add_u32 v51, v51, v207
  v_mfma_f32_16x16x32_bf16 v[160:163], v[108:111], a[192:195], v[160:163]
  v_mov_b32 v87, s41
  v_add_f32 v72, v72, v73
  v_mfma_f32_16x16x32_bf16 v[164:167], v[108:111], a[196:199], v[164:167]
  v_add_f32 v74, v74, v75
  v_add_f32 v85, v72, v74
  s_waitcnt vmcnt(12)
  v_mfma_f32_16x16x32_bf16 v[168:171], v[108:111], a[200:203], v[168:171]
  buffer_store_dwordx4 v[84:87], v15, s[44:47], 0 offen sc1
  buffer_store_dwordx4 v[84:87], v32, s[44:47], s5 offen
  v_mfma_f32_16x16x32_bf16 v[172:175], v[108:111], a[204:207], v[172:175]
  v_add_u32_dpp v56, v48, v48 row_ror:8 row_mask:0xf bank_mask:0x3
  v_add_u32_dpp v57, v49, v49 row_ror:8 row_mask:0xf bank_mask:0x3
  v_mfma_f32_16x16x32_bf16 v[176:179], v[108:111], a[208:211], v[176:179]
  v_add_u32_dpp v56, v50, v50 row_ror:8 row_mask:0xf bank_mask:0xc
  v_add_u32_dpp v57, v51, v51 row_ror:8 row_mask:0xf bank_mask:0xc
  v_mfma_f32_16x16x32_bf16 v[180:183], v[108:111], a[212:215], v[180:183]
  v_add_u32_dpp v60, v56, v56 row_shl:4 row_mask:0xf bank_mask:0x5
  s_nop 1
  v_add_u32_dpp v60, v57, v57 row_shr:4 row_mask:0xf bank_mask:0xa
  v_mfma_f32_16x16x32_bf16 v[184:187], v[108:111], a[216:219], v[184:187]
  s_nop 0
  v_add_u32_dpp v60, v60, v60 quad_perm:[1,0,3,2] row_mask:0xf bank_mask:0xf
  s_nop 1
  v_add_u32_dpp v60, v60, v60 quad_perm:[2,3,0,1] row_mask:0xf bank_mask:0xf
  v_mfma_f32_16x16x32_bf16 v[188:191], v[108:111], a[220:223], v[188:191]
  v_sub_u32 v60, s40, v60
  buffer_store_dword v60, v26, s[44:47], s75 offen sc1
  v_mfma_f32_16x16x32_bf16 v[160:163], v[116:119], a[224:227], v[160:163]
  v_mfma_f32_16x16x32_bf16 v[164:167], v[116:119], a[228:231], v[164:167]
  v_mfma_f32_16x16x32_bf16 v[168:171], v[116:119], a[232:235], v[168:171]
  v_mfma_f32_16x16x32_bf16 v[172:175], v[116:119], a[236:239], v[172:175]
  v_mfma_f32_16x16x32_bf16 v[176:179], v[116:119], a[240:243], v[176:179]
  v_mfma_f32_16x16x32_bf16 v[180:183], v[116:119], a[244:247], v[180:183]
  v_mfma_f32_16x16x32_bf16 v[184:187], v[116:119], a[248:251], v[184:187]
  v_mfma_f32_16x16x32_bf16 v[188:191], v[116:119], a[252:255], v[188:191]
  s_nop 1
  v_cvt_pk_bf16_f32 v208, v160, v164
  s_nop 0
  v_cvt_pk_bf16_f32 v209, v168, v172
  s_nop 0
  v_cvt_pk_bf16_f32 v210, v176, v180
  s_nop 0
  v_cvt_pk_bf16_f32 v211, v184, v188
  buffer_store_dwordx4 v[208:211], v25, s[44:47], 0 offen offset:0 sc1
  v_add3_u32 v52, v208, v209, v210
  v_add_u32 v52, v52, v211
  v_cvt_pk_bf16_f32 v212, v161, v165
  v_cvt_pk_bf16_f32 v213, v169, v173
  v_cvt_pk_bf16_f32 v214, v177, v181
  v_cvt_pk_bf16_f32 v215, v185, v189
  buffer_store_dwordx4 v[212:215], v25, s[44:47], 0 offen offset:1024 sc1
  v_add3_u32 v53, v212, v213, v214
  v_add_u32 v53, v53, v215
  v_cvt_pk_bf16_f32 v216, v162, v166
  v_cvt_pk_bf16_f32 v217, v170, v174
  v_cvt_pk_bf16_f32 v218, v178, v182
  v_cvt_pk_bf16_f32 v219, v186, v190
  buffer_store_dwordx4 v[216:219], v25, s[44:47], 0 offen offset:2048 sc1
  v_add3_u32 v54, v216, v217, v218
  v_add_u32 v54, v54, v219
  v_cvt_pk_bf16_f32 v220, v163, v167
  v_cvt_pk_bf16_f32 v221, v171, v175
  v_cvt_pk_bf16_f32 v222, v179, v183
  v_cvt_pk_bf16_f32 v223, v187, v191
  buffer_store_dwordx4 v[220:223], v25, s[44:47], 0 offen offset:3072 sc1
  v_add3_u32 v55, v220, v221, v222
  v_add_u32 v55, v55, v223
  v_add_u32_dpp v58, v52, v52 row_ror:8 row_mask:0xf bank_mask:0x3
  v_add_u32_dpp v59, v53, v53 row_ror:8 row_mask:0xf bank_mask:0x3
  s_nop 0
  v_add_u32_dpp v58, v54, v54 row_ror:8 row_mask:0xf bank_mask:0xc
  v_add_u32_dpp v59, v55, v55 row_ror:8 row_mask:0xf bank_mask:0xc
  s_nop 0
  v_add_u32_dpp v61, v58, v58 row_shl:4 row_mask:0xf bank_mask:0x5
  s_nop 1
  v_add_u32_dpp v61, v59, v59 row_shr:4 row_mask:0xf bank_mask:0xa
  s_nop 1
  v_add_u32_dpp v61, v61, v61 quad_perm:[1,0,3,2] row_mask:0xf bank_mask:0xf
  s_nop 1
  v_add_u32_dpp v61, v61, v61 quad_perm:[2,3,0,1] row_mask:0xf bank_mask:0xf
  v_sub_u32 v61, s40, v61
  buffer_store_dword v61, v27, s[44:47], s75 offen sc1
  s_branch L_T3
.p2align 12
L_FIN:
  s_cmp_ge_u32 s60, 10
  s_cbranch_scc1 L_END
  s_mov_b32 s48, s30
  s_and_b32 s49, s31, 0xffff
  s_mov_b32 s50, 1280
  s_mov_b32 s51, 0x20000
  s_cmp_eq_u32 s36, 0
  s_cselect_b32 s64, -1, 0
  v_and_b32 v32, s64, v28
  v_and_b32 v33, s64, v29
  v_and_b32 v34, s64, v30
  v_and_b32 v35, s64, v31
  v_pk_add_f32 v[192:193], v[192:193], v[196:197]
  v_pk_add_f32 v[194:195], v[194:195], v[198:199]
  v_mov_b32 v45, s40
  v_and_b32 v46, s3, v46
L_R_P1:
  buffer_load_dwordx4 v[64:67], v46, s[44:47], s79 offen sc1
  s_waitcnt vmcnt(0)
  v_max3_u32 v12, v64, v65, v66
  v_max_u32 v12, v12, v67
  v_cmp_eq_u32 vcc, -1, v12
  s_cbranch_vccz Lok_2
  s_sub_u32 s42, s42, 1
  s_cmp_eq_u32 s42, 0
  s_cbranch_scc1 L_END
  s_add_u32 s4, s4, 1
  s_cmp_ge_u32 s4, 96
  s_cselect_b32 s3, 4293918719, s3
  v_and_b32 v46, s3, v46
  s_sleep 1
  s_branch L_R_P1
Lok_2:
  v_and_b32 v48, s3, v48
  v_and_b32 v49, s3, v49
  v_and_b32 v50, s3, v50
  v_and_b32 v51, s3, v51
  v_mfma_f32_16x16x32_bf16 v[192:195], v[32:35], v[64:67], v[192:195]
  buffer_load_dwordx4 v[208:211], v48, s[44:47], s78 offen sc1
  buffer_load_dwordx4 v[212:215], v49, s[44:47], s78 offen sc1
  buffer_load_dwordx4 v[216:219], v50, s[44:47], s78 offen sc1
  buffer_load_dwordx4 v[220:223], v51, s[44:47], s78 offen sc1
  buffer_load_dwordx4 v[224:227], v48, s[44:47], s78 offen sc1
  buffer_load_dwordx4 v[228:231], v49, s[44:47], s78 offen sc1
  buffer_load_dwordx4 v[232:235], v50, s[44:47], s78 offen sc1
  buffer_load_dwordx4 v[236:239], v51, s[44:47], s78 offen sc1
L_R_P2:
  s_waitcnt vmcnt(4)
  v_mfma_f32_16x16x32_bf16 v[104:107], v[28:31], v[208:211], v[192:195]
  v_mfma_f32_16x16x32_bf16 v[104:107], v[28:31], v[212:215], v[104:107]
  v_mfma_f32_16x16x32_bf16 v[104:107], v[28:31], v[216:219], v[104:107]
  v_mfma_f32_16x16x32_bf16 v[104:107], v[28:31], v[220:223], v[104:107]
  v_max3_u32 v12, v208, v209, v210
  v_max3_u32 v12, v12, v211, v212
  v_max3_u32 v12, v12, v213, v214
  v_max3_u32 v12, v12, v215, v216
  v_max3_u32 v12, v12, v217, v218
  v_max3_u32 v12, v12, v219, v220
  v_max3_u32 v12, v12, v221, v222
  v_max_u32 v12, v12, v223
  v_cmp_eq_u32 vcc, -1, v12
  s_cbranch_vccz L_R_P2_OK
  buffer_load_dwordx4 v[208:211], v48, s[44:47], s78 offen sc1
  buffer_load_dwordx4 v[212:215], v49, s[44:47], s78 offen sc1
  buffer_load_dwordx4 v[216:219], v50, s[44:47], s78 offen sc1
  buffer_load_dwordx4 v[220:223], v51, s[44:47], s78 offen sc1
  s_waitcnt vmcnt(4)
  v_mfma_f32_16x16x32_bf16 v[104:107], v[28:31], v[224:227], v[192:195]
  v_mfma_f32_16x16x32_bf16 v[104:107], v[28:31], v[228:231], v[104:107]
  v_mfma_f32_16x16x32_bf16 v[104:107], v[28:31], v[232:235], v[104:107]
  v_mfma_f32_16x16x32_bf16 v[104:107], v[28:31], v[236:239], v[104:107]
  v_max3_u32 v12, v224, v225, v226
  v_max3_u32 v12, v12, v227, v228
  v_max3_u32 v12, v12, v229, v230
  v_max3_u32 v12, v12, v231, v232
  v_max3_u32 v12, v12, v233, v234
  v_max3_u32 v12, v12, v235, v236
  v_max3_u32 v12, v12, v237, v238
  v_max_u32 v12, v12, v239
  v_cmp_eq_u32 vcc, -1, v12
  s_cbranch_vccz L_R_P2_OK
  s_sub_u32 s42, s42, 1
  s_cmp_eq_u32 s42, 0
  s_cbranch_scc1 L_END
  s_add_u32 s4, s4, 1
  s_cmp_ge_u32 s4, 96
  s_cselect_b32 s3, 4293918719, s3
  v_and_b32 v48, s3, v48
  v_and_b32 v49, s3, v49
  v_and_b32 v50, s3, v50
  v_and_b32 v51, s3, v51
  buffer_load_dwordx4 v[224:227], v48, s[44:47], s78 offen sc1
  buffer_load_dwordx4 v[228:231], v49, s[44:47], s78 offen sc1
  buffer_load_dwordx4 v[232:235], v50, s[44:47], s78 offen sc1
  buffer_load_dwordx4 v[236:239], v51, s[44:47], s78 offen sc1
  s_branch L_R_P2
L_R_P2_OK:
  v_add_f32_dpp v104, v104, v104 row_ror:8 row_mask:0xf bank_mask:0xf
  v_add_f32_dpp v105, v105, v105 row_ror:8 row_mask:0xf bank_mask:0xf
  v_add_f32_dpp v106, v106, v106 row_ror:8 row_mask:0xf bank_mask:0xf
  v_add_f32_dpp v107, v107, v107 row_ror:8 row_mask:0xf bank_mask:0xf
  ds_write_b128 v52, v[104:107]
  s_waitcnt lgkmcnt(0)
  s_barrier
  s_cmp_lg_u32 s36, 0
  s_cbranch_scc1 L_END
  ds_read_b128 v[132:135], v54 offset:2560
  ds_read_b128 v[136:139], v54 offset:2816
  ds_read_b128 v[140:143], v54 offset:3072
  ds_read_b128 v[144:147], v54 offset:3328
  s_waitcnt lgkmcnt(2)
  v_pk_add_f32 v[132:133], v[132:133], v[136:137]
  v_pk_add_f32 v[134:135], v[134:135], v[138:139]
  s_waitcnt lgkmcnt(0)
  v_pk_add_f32 v[140:141], v[140:141], v[144:145]
  v_pk_add_f32 v[142:143], v[142:143], v[146:147]
  v_pk_add_f32 v[132:133], v[132:133], v[140:141]
  v_pk_add_f32 v[134:135], v[134:135], v[142:143]
  v_cvt_pk_bf16_f32 v128, v132, v133
  v_cvt_pk_bf16_f32 v129, v134, v135
  buffer_store_dwordx2 v[128:129], v53, s[48:51], s62 offen sc1
  s_cmp_lg_u32 s60, 0
  s_cbranch_scc1 L_END2
  buffer_store_dword v45, v55, s[44:47], 0 offen offset:0 sc1
L_END2:
  s_branch L_END
L_END:
L_EXIT:
s_endpgm
L_CODE_END:
.section .rodata,"a"
.p2align 6
.amdhsa_kernel sequential_preLN__compressed_kv_cla__dense_activation_squared_relu__decode_kernel
  .amdhsa_next_free_vgpr 512
  .amdhsa_next_free_sgpr 102
  .amdhsa_accum_offset 256
  .amdhsa_group_segment_fixed_size 0
  .amdhsa_kernarg_size 112
  .amdhsa_user_sgpr_count 2
  .amdhsa_user_sgpr_kernarg_segment_ptr 1
  .amdhsa_system_sgpr_workgroup_id_x 1
.end_amdhsa_kernel
```
